```python
import torch

def _softmax(x, axis=-1):
    return torch.softmax(x, dim=axis)
def _gelu(x):
    return torch.nn.functional.gelu(x, approximate="tanh")
def _silu(x):
    return torch.nn.functional.silu(x)
def _sigmoid(x):
    return torch.sigmoid(x)
def _layernorm(x, axis=-1, eps=1e-5):
    m = x.mean(dim=axis, keepdim=True)
    v = x.var(dim=axis, keepdim=True, unbiased=False)
    return (x - m) / torch.sqrt(v + eps)
def _scatter_add(tgt, idx, src, axis=0):
    return tgt.clone().index_add_(axis, idx, src)
def _segment_sum(src, seg, n):
    out = torch.zeros((n,) + src.shape[1:], dtype=src.dtype)
    return out.index_add_(0, seg, src)
def _pad(x, pw):
    flat = tuple(v for pair in reversed(pw) for v in pair)
    return torch.nn.functional.pad(x, flat)

kernel_name = 'standalone__cheap_equivariant_egnn__graph'

def setup_inputs():

    _w = (lambda a: (lambda t: t.to(torch.bfloat16) if t.is_floating_point() else t)(torch.as_tensor(a)))
    N, deg, D, De = 25000, 16, 128, max(4, 1)
    E = N * deg
    return {
        "h": _w((lambda *s: torch.randn(*s, dtype=torch.bfloat16) * 0.2)(N, D)),
        "pos": _w((lambda *s: torch.randn(*s, dtype=torch.bfloat16) * 0.8)(N, 3)),
        "e_attr": _w((lambda *s: torch.randn(*s, dtype=torch.bfloat16) * 0.8)(E, De)),
        "src": _w((lambda lo, hi, *s: torch.randint(lo, hi, s))(0, N, E).to(torch.int64)),
        "dst": _w((lambda lo, hi, *s: torch.randint(lo, hi, s))(0, N, E).to(torch.int64)),
        "w_e": _w(0.1 * (lambda *s: torch.randn(*s, dtype=torch.bfloat16) * 0.8)(2 * D + 1 + De, D)),
        "w_x": _w(0.1 * (lambda *s: torch.randn(*s, dtype=torch.bfloat16) * 0.2)(D, 1)),
        "w_h": _w(0.1 * (lambda *s: torch.randn(*s, dtype=torch.bfloat16) * 0.2)(2 * D, D)),
    }

def reference(h, pos, e_attr, src, dst, w_e, w_x, w_h):
    N, D = h.shape[0], h.shape[1]
    diff = pos[dst] - pos[src]
    dist2 = torch.sum(diff * diff, axis=-1, keepdims=True)
    e_in = torch.concatenate([h[dst], h[src], dist2, e_attr], axis=-1)
    m_ij = _silu(e_in @ w_e)
    coord_scale = m_ij @ w_x
    pos_new = pos + _segment_sum(diff * coord_scale, dst, N)
    m_i = _segment_sum(m_ij, dst, N)
    h_new = h + _silu(torch.concatenate([h, m_i], axis=-1) @ w_h)
    return h_new, pos_new
```

```asm
; @launch grid=(256,1,1) block=(512,1,1) lds=163840
.amdgcn_target "amdgcn-amd-amdhsa--gfx950"
.text
.globl standalone__cheap_equivariant_egnn__graph_kernel
.p2align 8
.type standalone__cheap_equivariant_egnn__graph_kernel,@function
standalone__cheap_equivariant_egnn__graph_kernel:
    s_cmp_ge_u32 s2, 256
    s_cbranch_scc1 K_END
    s_load_dwordx16 s[4:19], s[0:1], 0
    s_load_dwordx2 s[20:21], s[0:1], 64
    s_load_dwordx2 s[22:23], s[0:1], 80
    s_getpc_b64 s[96:97]
K_PC:
    v_lshrrev_b32 v232, 6, v0
    v_and_b32 v1, 63, v0
    v_lshl_add_u32 v236, v232, 5, v1
    v_lshlrev_b32 v236, 7, v236
    v_mov_b32 v237, 0
    v_lshl_add_u64 v[238:239], v[236:237], 0, s[96:97]
    s_mov_b32 exec_hi, 0
    global_load_dword v4, v[238:239], off
    s_mov_b32 exec_hi, -1
    v_readfirstlane_b32 s52, v232
    s_add_u32 s96, s96, silu_table-K_PC
    s_addc_u32 s97, s97, 0
    s_lshl_b32 s70, s52, 10
    s_lshr_b32 s3, s2, 3
    s_and_b32 s2, s2, 7
    s_lshl_b32 s2, s2, 5
    s_or_b32 s2, s2, s3
    s_mul_i32 s56, s2, 392
    v_mad_u32_u24 v233, v232, 49, v1
    v_add_u32 v233, s56, v233
    s_mov_b32 s57, 100000
    v_min_u32 v234, 99999, v233
    v_lshlrev_b32 v235, 5, v234
    v_lshlrev_b32 v234, 4, v234
    v_lshlrev_b32 v236, 2, v0
    v_and_b32 v236, 0x3ff, v236
    v_add_u32 v236, 52992, v236
    ds_write_b32 v236, v237
    s_mul_i32 s62, s2, 98
    s_sub_u32 s55, 25000, s62
    s_min_u32 s55, s55, 98
    s_lshl_b32 s59, s55, 8
    s_lshl_b32 s62, s62, 8
    v_lshrrev_b32 v240, 4, v1
    v_and_b32 v241, 15, v1
    v_xor_b32 v186, s52, v241
    v_lshlrev_b32 v186, 4, v186
    v_lshl_or_b32 v186, v240, 8, v186
    v_xor_b32 v187, 128, v186
    s_mov_b32 exec_hi, 0x1ffff
    v_cmp_gt_u32 s[92:93], s57, v233
    s_waitcnt lgkmcnt(0)
    global_load_dwordx4 v[40:43], v234, s[12:13] nt
    s_add_u32 s24, s4, s62
    s_addc_u32 s25, s5, 0
    s_and_b32 s25, s25, 0xffff
    s_mov_b32 s26, s59
    s_mov_b32 s27, 0x20000
    s_barrier
    global_load_dwordx4 v[44:47], v234, s[10:11] nt
    global_load_dwordx4 v[48:51], v235, s[8:9] nt
    global_load_dwordx4 v[52:55], v235, s[8:9] offset:16 nt
    s_mov_b32 exec_hi, -1
    s_mov_b32 s44, s14
    s_and_b32 s45, s15, 0xffff
    s_mov_b32 s46, 66816
    s_mov_b32 s47, 0x20000
    s_mov_b32 s48, s18
    s_and_b32 s49, s19, 0xffff
    s_mov_b32 s50, 65536
    s_mov_b32 s51, 0x20000
    s_mov_b32 s40, s6
    s_and_b32 s41, s7, 0xffff
    s_mov_b32 s42, 150000
    s_mov_b32 s43, 0x20000
    s_lshl_b32 s55, s3, 7
    v_lshl_add_u32 v236, v1, 12, s55
    s_cmp_eq_u32 s52, 0
    s_cbranch_scc1 K_PF_0
    s_cmp_eq_u32 s52, 1
    s_cbranch_scc1 K_PF_1
    s_cmp_eq_u32 s52, 2
    s_cbranch_scc1 K_PF_2
    s_cmp_eq_u32 s52, 3
    s_cbranch_scc1 K_PF_3
    s_sub_u32 s55, s52, 4
    s_cmp_le_u32 s55, 3
    s_cbranch_scc1 K_PF_4
    s_branch K_PF_X
K_PF_0:
    s_movk_i32 s55, 24576
    s_mov_b32 m0, 27392
    s_nop 0
    buffer_load_dwordx4 v187, s[24:27], s55 offen nt lds
    s_branch K_PF_X
K_PF_1:
    buffer_load_dword v4, v236, s[40:43], 0 offen
    s_branch K_PF_X
K_PF_2:
    buffer_load_dword v4, v236, s[48:51], 0 offen
    s_branch K_PF_X
K_PF_3:
    v_and_b32 v236, 0x3fff, v236
    v_lshl_add_u64 v[238:239], v[236:237], 0, s[96:97]
    s_mov_b64 exec, 15
    global_load_dword v4, v[238:239], off
    s_mov_b64 exec, -1
    s_branch K_PF_X
K_PF_4:
    buffer_load_dword v4, v236, s[44:47], 0 offen
K_PF_X:
    s_lshr_b32 s53, s52, 1
    s_and_b32 s54, s52, 1
    s_mov_b32 s65, 8192
    s_mov_b32 s66, 16384
    s_mov_b32 s67, 24576
    v_lshlrev_b32 v177, 2, v240
    v_xor_b32 v177, v177, v241
    v_lshlrev_b32 v177, 4, v177
    v_lshl_or_b32 v177, v240, 8, v177
    v_mov_b32 v10, 0x1000c
    v_lshlrev_b32 v13, 4, v1
    v_lshlrev_b32 v184, 4, v0
    v_mov_b32 v185, 12615680
    v_mov_b64 v[248:249], 0
    v_mov_b64 v[250:251], 0
    v_mov_b64 v[22:23], 0
    v_mov_b64 v[24:25], 0
    v_mov_b64 v[20:21], 0
    s_mul_i32 s55, s2, 18816
    s_add_u32 s55, s55, 6815744
    s_add_u32 s36, s22, s55
    s_addc_u32 s37, s23, 0
    s_and_b32 s37, s37, 0xffff
    s_mov_b32 s38, 18816
    s_mov_b32 s39, 0x20000
    v_and_b32 v188, 31, v1
    v_add_u32 v13, 52992, v13
    s_lshl_b32 s55, s52, 2
    s_add_u32 s55, s55, 992
    v_mov_b32 v19, s55
    v_mov_b64 v[120:121], 0
    s_cmp_eq_u32 s52, 2
    s_cbranch_scc1 K_J0_0
    s_branch K_J0_X
K_J0_0:
    s_lshr_b32 s55, s2, 1
    s_xor_b32 s55, s55, s2
    s_and_b32 s74, s55, 64
    s_bfe_u32 s55, s2, 0x20003
    s_lshl_b32 s55, s55, 4
    s_add_u32 s74, s74, s55
    s_bfe_u32 s55, s2, 0x10001
    s_lshl_b32 s55, s55, 1
    s_add_u32 s74, s74, s55
    s_bfe_u32 s55, s2, 0x10000
    s_lshl_b32 s55, s55, 2
    s_add_u32 s74, s74, s55
    s_bfe_u32 s55, s2, 0x10002
    s_lshl_b32 s55, s55, 3
    s_add_u32 s74, s74, s55
    s_lshl_b32 s74, s74, 8
    s_and_b32 s55, s2, 0x60
    s_lshl_b32 s55, s55, 1
    s_add_u32 s74, s74, s55
    s_add_u32 s74, s74, 32768
    v_lshl_add_u32 v120, v188, 1, s74
    s_and_b32 s75, s2, 63
    s_lshl_b32 s75, s75, 8
    s_and_b32 s55, s2, 64
    s_lshl_b32 s55, s55, 1
    s_add_u32 s75, s75, s55
    s_add_u32 s75, s75, 6422784
    v_lshl_add_u32 v121, v188, 2, s75
    s_bitcmp0_b32 s2, 7
    s_cbranch_scc1 K_WBA
    s_bfe_u32 s55, s2, 0x40003
    s_lshl_b32 s75, s55, 10
    s_bfe_u32 s55, s2, 0x10000
    s_lshl_b32 s55, s55, 9
    s_add_u32 s75, s75, s55
    s_bfe_u32 s55, s2, 0x20001
    s_lshl_b32 s55, s55, 2
    s_add_u32 s75, s75, s55
    s_add_u32 s75, s75, 12648448
    v_lshl_add_u32 v121, v188, 4, s75
K_WBA:
K_J0_X:
    s_mov_b32 s57, 42800
    s_movk_i32 s55, -98
    s_mov_b32 s56, 52992
    s_waitcnt vmcnt(4)
    v_mul_u32_u24 v56, s57, v40
    v_lshrrev_b32 v56, 22, v56
    v_mad_i32_i24 v40, v56, s55, v40
    v_lshl_add_u32 v56, v56, 2, s56
    v_mul_u32_u24 v57, s57, v41
    v_lshrrev_b32 v57, 22, v57
    v_mad_i32_i24 v41, v57, s55, v41
    v_lshl_add_u32 v57, v57, 2, s56
    v_mul_u32_u24 v58, s57, v42
    v_lshrrev_b32 v58, 22, v58
    v_mad_i32_i24 v42, v58, s55, v42
    v_lshl_add_u32 v58, v58, 2, s56
    v_mul_u32_u24 v59, s57, v43
    v_lshrrev_b32 v59, 22, v59
    v_mad_i32_i24 v43, v59, s55, v43
    v_lshl_add_u32 v59, v59, 2, s56
    s_mov_b64 exec, s[92:93]
    ds_add_rtn_u32 v60, v56, v10
    ds_add_rtn_u32 v61, v57, v10
    ds_add_rtn_u32 v62, v58, v10
    ds_add_rtn_u32 v63, v59, v10
    s_mov_b64 exec, -1
    v_add_u32 v40, 0x90, v40
    v_add_u32 v41, 0x90, v41
    v_add_u32 v42, 0x90, v42
    v_add_u32 v43, 0x90, v43
    s_waitcnt lgkmcnt(0)
    s_barrier
    ds_read_b128 v[64:67], v13
    v_and_b32 v60, 0xffff, v60
    v_add_u32 v60, 28416, v60
    v_and_b32 v61, 0xffff, v61
    v_add_u32 v61, 28416, v61
    v_and_b32 v62, 0xffff, v62
    v_add_u32 v62, 28416, v62
    v_and_b32 v63, 0xffff, v63
    v_add_u32 v63, 28416, v63
    s_waitcnt lgkmcnt(0)
    v_add_u32 v235, v64, v65
    v_add3_u32 v235, v235, v66, v67
    v_mov_b32 v236, v235
    s_nop 1
    v_add_u32_dpp v236, v236, v236 row_shr:1 row_mask:0xf bank_mask:0xf bound_ctrl:1
    s_nop 1
    v_add_u32_dpp v236, v236, v236 row_shr:2 row_mask:0xf bank_mask:0xf bound_ctrl:1
    s_nop 1
    v_add_u32_dpp v236, v236, v236 row_shr:4 row_mask:0xf bank_mask:0xf bound_ctrl:1
    s_nop 1
    v_add_u32_dpp v236, v236, v236 row_shr:8 row_mask:0xf bank_mask:0xf bound_ctrl:1
    s_nop 1
    v_add_u32_dpp v236, v236, v236 row_bcast:15 row_mask:0xa bank_mask:0xf
    s_nop 1
    v_add_u32_dpp v236, v236, v236 row_bcast:31 row_mask:0xc bank_mask:0xf
    v_sub_u32 v68, v236, v235
    v_add_u32 v69, v68, v64
    v_add_u32 v70, v69, v65
    v_add_u32 v71, v70, v66
    ds_write_b128 v13, v[68:71] offset:1024
    ds_read_u16 v56, v56 offset:1024
    ds_read_u16 v57, v57 offset:1024
    ds_read_u16 v58, v58 offset:1024
    ds_read_u16 v59, v59 offset:1024
    v_lshlrev_b32 v210, 19, v0
    v_add_u32 v210, 0x40008000, v210
    s_mov_b32 s55, 0x3fb8aa3b
    v_add_u32 v238, 0x60000, v210
    v_add_u32 v239, 0x70000, v210
    v_mul_f32 v238, s55, v238
    v_mul_f32 v239, s55, v239
    v_cvt_pk_bf16_f32 v213, v238, v239
    v_add_u32 v238, 0x40000, v210
    v_add_u32 v239, 0x50000, v210
    v_mul_f32 v238, s55, v238
    v_mul_f32 v239, s55, v239
    v_cvt_pk_bf16_f32 v212, v238, v239
    v_add_u32 v238, 0x20000, v210
    v_add_u32 v239, 0x30000, v210
    v_mul_f32 v238, s55, v238
    v_mul_f32 v239, s55, v239
    v_cvt_pk_bf16_f32 v211, v238, v239
    v_add_u32 v238, 0x0, v210
    v_add_u32 v239, 0x10000, v210
    v_mul_f32 v238, s55, v238
    v_mul_f32 v239, s55, v239
    v_cvt_pk_bf16_f32 v210, v238, v239
    s_mov_b32 s100, 0xbf7fbf80
    s_mov_b32 s101, 0xbf7fbf7f
    v_lshl_add_u64 v[210:211], v[210:211], 0, s[100:101]
    v_lshl_add_u64 v[212:213], v[212:213], 0, s[100:101]
    v_lshlrev_b32 v183, 4, v0
    v_add_u32 v183, 64256, v183
    ds_write_b128 v183, v[210:213] offset:0
    s_mov_b32 s100, 0x10001000
    s_mov_b32 s101, 0x10001000
    v_lshl_add_u64 v[210:211], v[210:211], 0, s[100:101]
    v_lshl_add_u64 v[212:213], v[212:213], 0, s[100:101]
    ds_write_b128 v183, v[210:213] offset:8192
    v_lshl_add_u64 v[210:211], v[210:211], 0, s[100:101]
    v_lshl_add_u64 v[212:213], v[212:213], 0, s[100:101]
    ds_write_b128 v183, v[210:213] offset:16384
    v_lshl_add_u64 v[210:211], v[210:211], 0, s[100:101]
    v_lshl_add_u64 v[212:213], v[212:213], 0, s[100:101]
    ds_write_b128 v183, v[210:213] offset:24576
    global_load_dword v185, v185, s[22:23] sc1
    s_cmp_eq_u32 s52, 1
    s_cbranch_scc1 K_J1_0
    s_cmp_eq_u32 s52, 2
    s_cbranch_scc1 K_J1_1
    s_cmp_eq_u32 s52, 3
    s_cbranch_scc1 K_J1_2
    s_sub_u32 s55, s52, 4
    s_cmp_le_u32 s55, 1
    s_cbranch_scc1 K_J1_3
    s_branch K_J1_X
K_J1_0:
    s_mov_b32 s55, 64512
    s_mov_b32 m0, 61184
    s_nop 0
    buffer_load_dwordx4 v184, s[44:47], s55 offen lds
    s_mov_b64 exec, 0xffff
    buffer_load_dwordx4 v184, s[44:47], s55 offen offset:1024 lds
    s_mov_b64 exec, -1
    s_branch K_J1_X
K_J1_1:
    buffer_load_ushort v122, v120, s[48:51], 0 offen
    buffer_load_short_d16_hi v123, v120, s[48:51], 0 offen offset:256
    s_branch K_J1_X
K_J1_2:
    v_lshlrev_b32 v120, 2, v1
    global_load_dword v122, v120, s[16:17]
    s_branch K_J1_X
K_J1_3:
    s_mul_i32 s55, s2, 588
    v_subrev_u32 v120, 256, v0
    v_min_u32 v120, 97, v120
    v_mad_u32_u24 v121, v120, 6, s55
    v_and_b32 v121, -4, v121
    buffer_load_dwordx2 v[122:123], v121, s[40:43], 0 offen
K_J1_X:
    s_add_u32 m0, s70, 97024
    s_add_u32 s63, s70, 32768
    buffer_load_dwordx4 v177, s[44:47], s63 offen lds
    s_add_u32 m0, s70, 105216
    s_add_u32 s63, s70, 40960
    buffer_load_dwordx4 v177, s[44:47], s63 offen lds
    s_add_u32 m0, s70, 113408
    s_add_u32 s63, s70, 49152
    buffer_load_dwordx4 v177, s[44:47], s63 offen lds
    s_add_u32 m0, s70, 121600
    s_add_u32 s63, s70, 57344
    buffer_load_dwordx4 v177, s[44:47], s63 offen lds
    s_add_u32 s55, s70, 0
    s_add_u32 m0, s55, 2816
    s_nop 0
    buffer_load_dwordx4 v186, s[24:27], s55 offen nt lds
    s_add_u32 s55, s70, 8192
    s_add_u32 m0, s55, 2816
    s_nop 0
    buffer_load_dwordx4 v187, s[24:27], s55 offen nt lds
    s_add_u32 s55, s70, 16384
    s_add_u32 m0, s55, 2816
    s_nop 0
    buffer_load_dwordx4 v186, s[24:27], s55 offen nt lds
    s_waitcnt vmcnt(11)
    v_lshl_or_b32 v44, v44, 8, v40
    v_lshl_or_b32 v45, v45, 8, v41
    v_lshl_or_b32 v46, v46, 8, v42
    v_lshl_or_b32 v47, v47, 8, v43
    v_add_u32 v234, 28416, v184
    s_waitcnt lgkmcnt(0)
    v_add_u32 v60, v60, v56
    v_add_u32 v61, v61, v57
    v_add_u32 v62, v62, v58
    v_add_u32 v63, v63, v59
    s_mov_b64 exec, s[92:93]
    ds_write_b32 v60, v44 offset:8
    ds_write_b32 v61, v45 offset:8
    ds_write_b32 v62, v46 offset:8
    ds_write_b32 v63, v47 offset:8
    s_waitcnt vmcnt(9)
    ds_write2_b32 v60, v48, v49 offset0:0 offset1:1
    ds_write2_b32 v61, v50, v51 offset0:0 offset1:1
    ds_write2_b32 v62, v52, v53 offset0:0 offset1:1
    ds_write2_b32 v63, v54, v55 offset0:0 offset1:1
    s_mov_b64 exec, -1
    s_waitcnt lgkmcnt(0)
    s_barrier
    ds_read_b128 v[236:239], v234 offset:0
    ds_read_b128 v[240:243], v234 offset:8192
    ds_read_b128 v[244:247], v234 offset:16384
    s_waitcnt lgkmcnt(2)
    buffer_store_dwordx4 v[236:239], v184, s[36:39], 0 offen sc0 sc1
    s_waitcnt lgkmcnt(1)
    buffer_store_dwordx4 v[240:243], v184, s[36:39], s65 offen sc0 sc1
    s_waitcnt lgkmcnt(0)
    buffer_store_dwordx4 v[244:247], v184, s[36:39], s66 offen sc0 sc1
    s_nop 1
    s_add_u32 s28, s20, s62
    s_addc_u32 s29, s21, 0
    s_and_b32 s29, s29, 0xffff
    s_mov_b32 s30, s59
    s_mov_b32 s31, 0x20000
    s_add_u32 s62, s62, 256
    s_add_u32 s32, s22, s62
    s_addc_u32 s33, s23, 0
    s_and_b32 s33, s33, 0xffff
    s_mov_b32 s34, s59
    s_mov_b32 s35, 0x20000
    v_lshrrev_b32 v232, 5, v1
    v_and_b32 v188, 31, v1
    v_and_b32 v235, 3, v1
    v_mov_b32 v17, 4
    v_lshl_add_u32 v234, v188, 2, s53
    v_min_u32 v234, 99, v234
    v_bfe_u32 v237, v234, 2, 4
    v_xor_b32 v237, v237, v232
    v_lshlrev_b32 v237, 4, v237
    v_lshl_add_u32 v176, v234, 8, v237
    v_bfe_u32 v234, v1, 2, 2
    v_bfe_u32 v236, v1, 4, 1
    v_lshlrev_b32 v237, 8, v234
    v_lshl_add_u32 v237, v236, 5, v237
    v_lshl_add_u32 v237, v235, 3, v237
    s_lshl_b32 s56, s54, 7
    v_add_u32 v182, s56, v237
    s_mov_b32 exec_lo, 0
    v_add_u32 v182, 60416, v182
    s_mov_b32 exec_hi, 0x0fff0fff
    v_mov_b32 v182, 0x100000
    s_mov_b32 exec_lo, -1
    s_mov_b32 exec_hi, 0
    v_add_u32 v182, 61440, v182
    s_mov_b64 exec, -1
    s_lshl_b32 s55, s54, 1
    v_xor_b32 v238, s55, v234
    v_lshl_add_u32 v238, v238, 6, v237
    v_lshl_add_u32 v180, v232, 11, v238
    v_xor_b32 v181, 64, v180
    v_add_u32 v178, 97024, v180
    v_add_u32 v179, 97024, v181
    v_lshl_add_u32 v238, v232, 2, v234
    v_lshrrev_b32 v239, 1, v235
    v_lshl_add_u32 v239, v236, 1, v239
    v_lshl_add_u32 v239, s54, 3, v239
    v_xor_b32 v239, v239, v238
    v_lshlrev_b32 v239, 4, v239
    v_lshl_add_u32 v238, v238, 2, s53
    v_lshl_add_u32 v239, v238, 8, v239
    v_and_b32 v238, 1, v1
    v_lshl_add_u32 v192, v238, 3, v239
    v_xor_b32 v193, 64, v192
    v_xor_b32 v194, 128, v192
    v_xor_b32 v195, 192, v192
    v_lshlrev_b32 v11, 4, v232
    v_lshl_add_u32 v15, s56, 1, v11
    v_add_u32 v11, 512, v11
    v_lshl_add_u32 v236, v236, 2, v235
    v_add_u32 v236, 1, v236
    v_lshlrev_b32 v236, 21, v236
    v_bfe_u32 v234, v1, 2, 1
    v_lshl_add_u32 v234, v234, 1, v232
    v_bfe_u32 v237, v1, 3, 1
    v_lshlrev_b32 v237, 4, v237
    v_lshl_add_u32 v7, v234, 5, v237
    v_add_u32 v7, 640, v7
    v_lshl_add_u32 v9, v234, 6, v237
    v_sub_u32 v9, v9, v236
    v_lshlrev_b32 v8, 4, v188
    v_sub_u32 v12, 0, v232
    v_and_b32 v12, 0x04040606, v12
    v_add_u32 v12, 0x03020100, v12
    v_lshlrev_b32 v18, 4, v232
    s_mov_b32 s10, 0xfff80000
    v_and_b32 v6, 12, v188
    v_lshlrev_b32 v6, 3, v6
    v_and_b32 v234, 1, v188
    v_lshl_add_u32 v6, v234, 4, v6
    v_lshrrev_b32 v234, 4, v188
    v_lshl_add_u32 v6, v234, 3, v6
    v_and_b32 v234, 2, v188
    v_lshl_add_u32 v6, v234, 1, v6
    v_add_u32 v6, 640, v6
    s_lshl_b32 s55, s53, 8
    s_add_u32 s55, s55, s56
    v_lshlrev_b32 v14, 2, v188
    v_lshl_add_u32 v14, v232, 12, v14
    v_add_u32 v14, s55, v14
    s_mul_i32 s64, s53, 15360
    s_add_u32 s64, s64, 2816
    s_mov_b32 s58, 0
    s_mov_b32 s60, 0
    s_mov_b64 s[84:85], 0
    s_mov_b64 s[86:87], 0
    s_mov_b64 s[88:89], 0
    s_mov_b64 s[90:91], 0
    s_lshr_b32 s56, s2, 2
    s_lshl_b32 s56, s56, 4
    s_and_b32 s55, s2, 1
    s_lshl_b32 s55, s55, 3
    s_add_u32 s56, s56, s55
    s_and_b32 s55, s2, 2
    s_lshl_b32 s55, s55, 9
    s_add_u32 s56, s56, s55
    s_lshl_b32 s55, s52, 16
    s_add_u32 s55, s55, s56
    s_add_u32 s55, s55, 12058624
    v_lshl_add_u32 v208, v1, 11, s55
    s_lshl_b32 s56, s54, 7
    s_add_u32 s56, s56, 128
    s_add_u32 s4, s22, s56
    s_addc_u32 s5, s23, 0
    s_and_b32 s5, s5, 0xffff
    s_or_b32 s5, s5, 0x40000
    s_mov_b32 s6, -1
    s_mov_b32 s7, 0x800000
    s_lshl_b32 s56, s54, 13
    s_add_u32 s56, s56, 12648448
    s_add_u32 s12, s22, s56
    s_addc_u32 s13, s23, 0
    s_and_b32 s13, s13, 0xffff
    s_mov_b32 s14, 8192
    s_mov_b32 s15, 0x20000
    s_add_u32 s16, s20, 6400000
    s_addc_u32 s17, s21, 0
    s_and_b32 s17, s17, 0xffff
    s_mov_b32 s18, 150000
    s_mov_b32 s19, 0x20000
    s_add_u32 s36, s22, 6815744
    s_addc_u32 s37, s23, 0
    s_and_b32 s37, s37, 0xffff
    s_mov_b32 s38, 4816896
    s_mov_b32 s39, 0x20000
    v_and_b32 v214, 0xff, v0
    v_lshlrev_b32 v214, 6, v214
    v_add_u32 v214, 12713984, v214
    s_cmp_eq_u32 s52, 3
    s_cbranch_scc1 K_J3_0
    s_branch K_J3_X
K_J3_0:
    v_lshrrev_b32 v237, 3, v1
    v_subrev_u32 v238, 1, v237
    v_and_b32 v239, 1, v238
    v_lshrrev_b32 v236, 2, v238
    v_lshl_add_u32 v239, v239, 2, v236
    v_and_b32 v236, 7, v1
    v_cmp_eq_u32 s[94:95], v236, v239
    v_and_b32 v238, 2, v238
    v_lshlrev_b32 v238, 3, v238
    v_mov_b32 v236, 0x3f80
    v_lshlrev_b32 v236, v238, v236
    v_cndmask_b32 v236, 0, v236, s[94:95]
    v_lshlrev_b32 v239, 2, v1
    ds_write_b32 v239, v236 offset:0
    v_bfe_u32 v234, v1, 2, 1
    v_lshl_add_u32 v237, v237, 2, v235
    v_lshlrev_b32 v237, 9, v237
    v_lshl_add_u32 v237, v234, 7, v237
    v_add_u32 v237, 6422656, v237
    v_lshlrev_b32 v238, 2, v188
    v_lshl_add_u32 v238, v232, 8, v238
    ds_write_b32 v238, v237 offset:768
K_J3_X:
    s_waitcnt vmcnt(3)
    v_readfirstlane_b32 s71, v185
    s_add_u32 s71, s71, 0x9e3779b9
    s_lshl_b32 s72, s71, 22
    s_cmp_eq_u32 s52, 0
    s_cbranch_scc1 K_J2_0
    s_cmp_eq_u32 s52, 3
    s_cbranch_scc1 K_J2_1
    s_sub_u32 s55, s52, 4
    s_cmp_le_u32 s55, 1
    s_cbranch_scc1 K_J2_2
    s_cmp_eq_u32 s52, 2
    s_cbranch_scc1 K_J2_3
    s_branch K_J2_X
K_J2_0:
    v_lshrrev_b32 v64, 5, v64
    v_and_b32 v64, 0x3ff800, v64
    v_lshrrev_b32 v68, 16, v68
    v_or3_b32 v40, v64, v68, s72
    v_mov_b32 v41, s71
    v_lshrrev_b32 v65, 5, v65
    v_and_b32 v65, 0x3ff800, v65
    v_lshrrev_b32 v69, 16, v69
    v_or3_b32 v42, v65, v69, s72
    v_mov_b32 v43, s71
    v_lshrrev_b32 v66, 5, v66
    v_and_b32 v66, 0x3ff800, v66
    v_lshrrev_b32 v70, 16, v70
    v_or3_b32 v44, v66, v70, s72
    v_mov_b32 v45, s71
    v_lshrrev_b32 v67, 5, v67
    v_and_b32 v67, 0x3ff800, v67
    v_lshrrev_b32 v71, 16, v71
    v_or3_b32 v46, v67, v71, s72
    v_mov_b32 v47, s71
    s_branch K_J2_X
K_J2_1:
    v_lshlrev_b32 v120, 3, v1
    v_and_b32 v123, 0xffff0000, v122
    v_lshlrev_b32 v122, 16, v122
    ds_write_b64 v120, v[122:123] offset:256
    s_branch K_J2_X
K_J2_2:
    v_lshlrev_b32 v121, 4, v120
    v_and_b32 v124, 16, v121
    v_lshrrev_b64 v[122:123], v124, v[122:123]
    v_lshlrev_b32 v124, 16, v122
    v_and_b32 v125, 0xffff0000, v122
    v_lshlrev_b32 v126, 16, v123
    v_lshrrev_b32 v127, 1, v120
    v_and_b32 v127, 6, v127
    v_perm_b32 v127, v127, v127, 0
    v_xor_b32 v127, 0x03020100, v127
    ds_write_b128 v121, v[124:127] offset:1152
    s_branch K_J2_X
K_J2_3:
    v_or_b32 v122, v123, v122
    global_store_dword v121, v122, s[22:23] sc0 sc1
    v_lshlrev_b32 v120, 2, v1
    s_cmp_lg_u32 s2, 0
    s_cbranch_scc1 K_J2_X
    global_store_dword v120, v248, s[22:23] sc0 sc1
K_J2_X:
    s_lshl_b32 s55, s2, 11
    s_add_u32 s55, s55, 12058624
    v_lshl_add_u32 v232, v1, 4, s55
    s_cmp_eq_u32 s52, 2
    s_cbranch_scc1 K_B4A
    s_waitcnt vmcnt(0)
K_B4A:
    s_waitcnt vmcnt(1)
    s_barrier
    s_cmp_lg_u32 s52, 0
    s_cbranch_scc1 K_NOMA
    global_store_dwordx4 v232, v[40:43], s[22:23] sc0 sc1
    global_store_dwordx4 v232, v[44:47], s[22:23] offset:1024 sc0 sc1
K_NOMA:
    v_xor_b32 v4, 0, v176
    ds_read_b128 v[144:147], v4 offset:2816
    ds_read_b64_tr_b16 v[128:129], v178 offset:0
    ds_read_b64_tr_b16 v[130:131], v178 offset:1024
    ds_read_b64_tr_b16 v[132:133], v179 offset:0
    ds_read_b64_tr_b16 v[134:135], v179 offset:1024
    v_xor_b32 v4, 32, v176
    ds_read_b128 v[148:151], v4 offset:2816
    ds_read_b64_tr_b16 v[136:137], v178 offset:4096
    ds_read_b64_tr_b16 v[138:139], v178 offset:5120
    ds_read_b64_tr_b16 v[140:141], v179 offset:4096
    ds_read_b64_tr_b16 v[142:143], v179 offset:5120
    s_waitcnt lgkmcnt(5)
    v_mfma_f32_32x32x16_bf16 v[72:87], v[144:147], v[128:131], 0
    v_xor_b32 v4, 64, v176
    ds_read_b128 v[152:155], v4 offset:2816
    ds_read_b64_tr_b16 v[184:185], v178 offset:8192
    ds_read_b64_tr_b16 v[186:187], v178 offset:9216
    ds_read_b64_tr_b16 v[188:189], v179 offset:8192
    ds_read_b64_tr_b16 v[190:191], v179 offset:9216
    v_lshrrev_b32 v232, 2, v8
    ds_write_b32 v232, v248 offset:896
    ds_read_b64_tr_b16 v[38:39], v194 offset:27392
    ds_read_b64_tr_b16 v[196:197], v195 offset:27392
    v_mfma_f32_32x32x16_bf16 v[88:103], v[144:147], v[132:135], 0
    s_add_u32 m0, s70, 129792
    s_add_u32 s63, s70, 0
    buffer_load_dwordx4 v177, s[44:47], s63 offen lds
    s_waitcnt lgkmcnt(8)
    v_mfma_f32_32x32x16_bf16 v[72:87], v[148:151], v[136:139], v[72:87]
    v_xor_b32 v4, 96, v176
    ds_read_b128 v[156:159], v4 offset:2816
    ds_read_b64_tr_b16 v[128:129], v178 offset:12288
    ds_read_b64_tr_b16 v[130:131], v178 offset:13312
    ds_read_b64_tr_b16 v[132:133], v179 offset:12288
    ds_read_b64_tr_b16 v[134:135], v179 offset:13312
    v_mfma_f32_32x32x16_bf16 v[88:103], v[148:151], v[140:143], v[88:103]
    s_add_u32 m0, s70, 137984
    s_add_u32 s63, s70, 8192
    buffer_load_dwordx4 v177, s[44:47], s63 offen lds
    s_waitcnt lgkmcnt(8)
    v_mfma_f32_32x32x16_bf16 v[72:87], v[152:155], v[184:187], v[72:87]
    v_xor_b32 v4, 128, v176
    ds_read_b128 v[160:163], v4 offset:2816
    ds_read_b64_tr_b16 v[136:137], v178 offset:16384
    ds_read_b64_tr_b16 v[138:139], v178 offset:17408
    ds_read_b64_tr_b16 v[140:141], v179 offset:16384
    ds_read_b64_tr_b16 v[142:143], v179 offset:17408
    ds_read_b64_tr_b16 v[26:27], v192 offset:2816
    ds_read_b64_tr_b16 v[32:33], v193 offset:2816
    v_mfma_f32_32x32x16_bf16 v[88:103], v[152:155], v[188:191], v[88:103]
    s_add_u32 m0, s70, 146176
    s_add_u32 s63, s70, 16384
    buffer_load_dwordx4 v177, s[44:47], s63 offen lds
    s_waitcnt lgkmcnt(7)
    v_mfma_f32_32x32x16_bf16 v[72:87], v[156:159], v[128:131], v[72:87]
    v_xor_b32 v4, 160, v176
    ds_read_b128 v[164:167], v4 offset:2816
    ds_read_b64_tr_b16 v[184:185], v178 offset:20480
    ds_read_b64_tr_b16 v[186:187], v178 offset:21504
    ds_read_b64_tr_b16 v[188:189], v179 offset:20480
    ds_read_b64_tr_b16 v[190:191], v179 offset:21504
    s_add_u32 m0, s70, 154368
    s_add_u32 s63, s70, 24576
    buffer_load_dwordx4 v177, s[44:47], s63 offen lds
    v_mfma_f32_32x32x16_bf16 v[88:103], v[156:159], v[132:135], v[88:103]
    ds_read_b64_tr_b16 v[28:29], v194 offset:11008
    ds_read_b64_tr_b16 v[34:35], v195 offset:11008
    s_waitcnt lgkmcnt(9)
    v_mfma_f32_32x32x16_bf16 v[72:87], v[160:163], v[136:139], v[72:87]
    v_xor_b32 v4, 192, v176
    ds_read_b128 v[168:171], v4 offset:2816
    ds_read_b64_tr_b16 v[128:129], v178 offset:24576
    ds_read_b64_tr_b16 v[130:131], v178 offset:25600
    ds_read_b64_tr_b16 v[132:133], v179 offset:24576
    ds_read_b64_tr_b16 v[134:135], v179 offset:25600
    s_add_u32 m0, s70, 28416
    s_add_u32 s63, s70, 0
    buffer_load_dwordx4 v177, s[48:51], s63 offen lds
    v_mfma_f32_32x32x16_bf16 v[88:103], v[160:163], v[140:143], v[88:103]
    s_add_u32 m0, s70, 36608
    s_add_u32 s63, s70, 8192
    buffer_load_dwordx4 v177, s[48:51], s63 offen lds
    s_waitcnt lgkmcnt(7)
    v_mfma_f32_32x32x16_bf16 v[72:87], v[164:167], v[184:187], v[72:87]
    v_xor_b32 v4, 224, v176
    ds_read_b128 v[172:175], v4 offset:2816
    ds_read_b64_tr_b16 v[136:137], v178 offset:28672
    ds_read_b64_tr_b16 v[138:139], v178 offset:29696
    ds_read_b64_tr_b16 v[140:141], v179 offset:28672
    ds_read_b64_tr_b16 v[142:143], v179 offset:29696
    v_mfma_f32_32x32x16_bf16 v[88:103], v[164:167], v[188:191], v[88:103]
    ds_read_b64_tr_b16 v[30:31], v192 offset:19200
    ds_read_b64_tr_b16 v[36:37], v193 offset:19200
    s_waitcnt lgkmcnt(7)
    v_mfma_f32_32x32x16_bf16 v[72:87], v[168:171], v[128:131], v[72:87]
    s_add_u32 m0, s70, 44800
    s_add_u32 s63, s70, 16384
    buffer_load_dwordx4 v177, s[48:51], s63 offen lds
    v_mfma_f32_32x32x16_bf16 v[88:103], v[168:171], v[132:135], v[88:103]
    s_add_u32 m0, s70, 52992
    s_add_u32 s63, s70, 24576
    buffer_load_dwordx4 v177, s[48:51], s63 offen lds
    s_waitcnt lgkmcnt(2)
    v_mfma_f32_32x32x16_bf16 v[72:87], v[172:175], v[136:139], v[72:87]
    v_mov_b32 v39, v196
    v_mfma_f32_32x32x16_bf16 v[88:103], v[172:175], v[140:143], v[88:103]
    s_add_u32 s74, s70, 2816
    s_waitcnt vmcnt(4) lgkmcnt(0)
    s_barrier
    s_mov_b32 exec_hi, 0
    global_load_dwordx2 v[20:21], v208, s[22:23] sc1
    s_mov_b32 exec_hi, -1
    v_lshl_add_u32 v215, v1, 4, s74
    ds_write_b128 v215, v[248:251]
    s_nop 1
    s_mov_b32 s55, 0x3fb8aa3b
    s_mov_b32 s57, 0x7fff0000
    v_mul_f32 v88, s55, v88
    v_cvt_pk_bf16_f32 v72, v72, v88
    v_and_b32 v88, 0x7fffffff, v88
    v_add_u32 v88, 0x8000, v88
    v_sub_u32_sdwa v88, v88, v72 clamp dst_sel:DWORD dst_unused:UNUSED_PAD src0_sel:DWORD src1_sel:WORD_0
    v_bfi_b32 v72, s57, v88, v72
    v_mul_f32 v89, s55, v89
    v_cvt_pk_bf16_f32 v73, v73, v89
    v_and_b32 v89, 0x7fffffff, v89
    v_add_u32 v89, 0x8000, v89
    v_sub_u32_sdwa v89, v89, v73 clamp dst_sel:DWORD dst_unused:UNUSED_PAD src0_sel:DWORD src1_sel:WORD_0
    v_bfi_b32 v73, s57, v89, v73
    buffer_store_dword v72, v14, s[32:35], 0 offen offset:0 sc0 sc1
    buffer_store_dword v73, v14, s[32:35], 0 offen offset:1024 sc0 sc1
    v_mul_f32 v90, s55, v90
    v_cvt_pk_bf16_f32 v74, v74, v90
    v_and_b32 v90, 0x7fffffff, v90
    v_add_u32 v90, 0x8000, v90
    v_sub_u32_sdwa v90, v90, v74 clamp dst_sel:DWORD dst_unused:UNUSED_PAD src0_sel:DWORD src1_sel:WORD_0
    v_bfi_b32 v74, s57, v90, v74
    v_mul_f32 v91, s55, v91
    v_cvt_pk_bf16_f32 v75, v75, v91
    v_and_b32 v91, 0x7fffffff, v91
    v_add_u32 v91, 0x8000, v91
    v_sub_u32_sdwa v91, v91, v75 clamp dst_sel:DWORD dst_unused:UNUSED_PAD src0_sel:DWORD src1_sel:WORD_0
    v_bfi_b32 v75, s57, v91, v75
    buffer_store_dword v74, v14, s[32:35], 0 offen offset:2048 sc0 sc1
    buffer_store_dword v75, v14, s[32:35], 0 offen offset:3072 sc0 sc1
    s_mov_b32 exec_hi, 0
    s_mov_b32 s57, 0
    s_waitcnt vmcnt(4)
K_POLLA:
    v_xor_b32 v232, s72, v20
    v_lshrrev_b32 v232, 22, v232
    v_xor_b32 v233, s71, v21
    v_or_b32 v232, v232, v233
    v_cmp_ne_u32 vcc, 0, v232
    s_add_u32 s57, s57, 1
    s_cbranch_vccz K_HAVEA
    s_cmp_gt_u32 s57, 400000
    s_cbranch_scc1 K_END
    s_mov_b64 exec, vcc
    global_load_dwordx2 v[20:21], v208, s[22:23] sc1
    s_waitcnt vmcnt(0)
    s_branch K_POLLA
K_ROUND:
    s_add_u32 s74, s70, 2816
    v_lshl_add_u32 v215, v1, 4, s74
    ds_write_b128 v215, v[248:251]
    v_lshrrev_b32 v232, 2, v8
    ds_write_b32 v232, v248 offset:896
    s_waitcnt lgkmcnt(0)
    s_barrier
K_HAVEA:
    s_mov_b64 exec, -1
    v_bfe_u32 v232, v20, 11, 11
    v_mov_b32 v233, v232
    s_lshl_b32 s55, s52, 5
    v_add_u32 v234, s55, v1
    v_and_b32 v235, 0x7ff, v20
    s_movk_i32 s55, 1568
    v_mad_u32_u24 v234, v234, s55, v235
    s_nop 1
    v_add_u32_dpp v233, v233, v233 row_shr:1 row_mask:0xf bank_mask:0xf bound_ctrl:1
    s_nop 1
    v_add_u32_dpp v233, v233, v233 row_shr:2 row_mask:0xf bank_mask:0xf bound_ctrl:1
    s_nop 1
    v_add_u32_dpp v233, v233, v233 row_shr:4 row_mask:0xf bank_mask:0xf bound_ctrl:1
    s_nop 1
    v_add_u32_dpp v233, v233, v233 row_shr:8 row_mask:0xf bank_mask:0xf bound_ctrl:1
    s_nop 1
    v_add_u32_dpp v233, v233, v233 row_bcast:15 row_mask:0xa bank_mask:0xf
    v_cmp_ne_u32 vcc, 0, v232
    v_readlane_b32 s59, v233, 31
    v_sub_u32 v233, v233, v232
    v_sub_u32 v234, v234, v233
    v_sub_u32 v233, v233, s58 clamp
    s_movk_i32 s55, 256
    v_cmp_gt_u32 s[94:95], s55, v233
    v_lshl_add_u32 v233, v233, 2, s74
    s_and_b64 exec, vcc, s[94:95]
    ds_max_u32 v233, v234
    s_mov_b64 exec, -1
    ds_read_b128 v[240:243], v215
    v_lshl_add_u32 v238, v1, 2, s74
    v_mov_b32 v233, 0
    s_waitcnt lgkmcnt(0)
    v_max3_u32 v232, v240, v241, v242
    v_max_u32 v232, v232, v243
    s_nop 1
    v_max_u32_dpp v232, v232, v232 row_shr:1 row_mask:0xf bank_mask:0xf bound_ctrl:1
    s_nop 1
    v_max_u32_dpp v232, v232, v232 row_shr:2 row_mask:0xf bank_mask:0xf bound_ctrl:1
    s_nop 1
    v_max_u32_dpp v232, v232, v232 row_shr:4 row_mask:0xf bank_mask:0xf bound_ctrl:1
    s_nop 1
    v_max_u32_dpp v232, v232, v232 row_shr:8 row_mask:0xf bank_mask:0xf bound_ctrl:1
    s_nop 1
    v_max_u32_dpp v232, v232, v232 row_bcast:15 row_mask:0xa bank_mask:0xf
    s_nop 1
    v_max_u32_dpp v232, v232, v232 row_bcast:31 row_mask:0xc bank_mask:0xf
    s_nop 1
    v_mov_b32_dpp v233, v232 wave_shr:1 row_mask:0xf bank_mask:0xf
    v_max_u32 v240, v240, v233
    v_max_u32 v241, v241, v240
    v_max_u32 v242, v242, v241
    v_max_u32 v243, v243, v242
    ds_write_b128 v215, v[240:243]
    ds_read_b32 v244, v238 offset:0
    ds_read_b32 v245, v238 offset:256
    ds_read_b32 v246, v238 offset:512
    ds_read_b32 v247, v238 offset:768
    v_add_u32 v232, s58, v1
    v_mov_b32 v237, -16
    v_cmp_gt_u32 vcc, s59, v232
    s_waitcnt lgkmcnt(3)
    v_add_u32 v233, v232, v244
    v_mul_u32_u24 v233, 12, v233
    s_andn2_b64 s[76:77], vcc, s[84:85]
    v_cndmask_b32 v233, v237, v233, s[76:77]
    v_add_u32 v232, 64, v232
    v_cmp_gt_u32 vcc, s59, v232
    s_waitcnt lgkmcnt(2)
    v_add_u32 v234, v232, v245
    v_mul_u32_u24 v234, 12, v234
    s_andn2_b64 s[78:79], vcc, s[86:87]
    v_cndmask_b32 v234, v237, v234, s[78:79]
    v_add_u32 v232, 64, v232
    v_cmp_gt_u32 vcc, s59, v232
    s_waitcnt lgkmcnt(1)
    v_add_u32 v235, v232, v246
    v_mul_u32_u24 v235, 12, v235
    s_andn2_b64 s[80:81], vcc, s[88:89]
    v_cndmask_b32 v235, v237, v235, s[80:81]
    v_add_u32 v232, 64, v232
    v_cmp_gt_u32 vcc, s59, v232
    s_waitcnt lgkmcnt(0)
    v_add_u32 v236, v232, v247
    v_mul_u32_u24 v236, 12, v236
    s_andn2_b64 s[82:83], vcc, s[90:91]
    v_cndmask_b32 v236, v237, v236, s[82:83]
    buffer_load_dwordx3 v[216:218], v233, s[36:39], 0 offen sc1
    buffer_load_dwordx3 v[220:222], v234, s[36:39], 0 offen sc1
    buffer_load_dwordx3 v[224:226], v235, s[36:39], 0 offen sc1
    buffer_load_dwordx3 v[228:230], v236, s[36:39], 0 offen sc1
    s_cmp_lg_u32 s60, 0
    s_cbranch_scc1 K_NOA
    ds_read_b64_tr_b16 v[128:129], v178 offset:32768
    ds_read_b64_tr_b16 v[130:131], v178 offset:33792
    ds_read_b64_tr_b16 v[132:133], v179 offset:32768
    ds_read_b64_tr_b16 v[134:135], v179 offset:33792
    ds_read_b64_tr_b16 v[136:137], v178 offset:36864
    ds_read_b64_tr_b16 v[138:139], v178 offset:37888
    ds_read_b64_tr_b16 v[140:141], v179 offset:36864
    ds_read_b64_tr_b16 v[142:143], v179 offset:37888
    s_waitcnt lgkmcnt(4)
    v_mfma_f32_32x32x16_bf16 v[40:55], v[144:147], v[128:131], 0
    ds_read_b64_tr_b16 v[184:185], v178 offset:40960
    ds_read_b64_tr_b16 v[186:187], v178 offset:41984
    ds_read_b64_tr_b16 v[188:189], v179 offset:40960
    ds_read_b64_tr_b16 v[190:191], v179 offset:41984
    s_mov_b32 s55, 0x3fb8aa3b
    s_mov_b32 s57, 0x7fff0000
    v_mul_f32 v92, s55, v92
    v_cvt_pk_bf16_f32 v76, v76, v92
    v_and_b32 v92, 0x7fffffff, v92
    v_mfma_f32_32x32x16_bf16 v[56:71], v[144:147], v[132:135], 0
    v_add_u32 v92, 0x8000, v92
    v_sub_u32_sdwa v92, v92, v76 clamp dst_sel:DWORD dst_unused:UNUSED_PAD src0_sel:DWORD src1_sel:WORD_0
    v_bfi_b32 v76, s57, v92, v76
    v_mul_f32 v93, s55, v93
    s_waitcnt lgkmcnt(4)
    v_mfma_f32_32x32x16_bf16 v[40:55], v[148:151], v[136:139], v[40:55]
    ds_read_b64_tr_b16 v[128:129], v178 offset:45056
    ds_read_b64_tr_b16 v[130:131], v178 offset:46080
    ds_read_b64_tr_b16 v[132:133], v179 offset:45056
    ds_read_b64_tr_b16 v[134:135], v179 offset:46080
    v_cvt_pk_bf16_f32 v77, v77, v93
    v_and_b32 v93, 0x7fffffff, v93
    v_add_u32 v93, 0x8000, v93
    v_sub_u32_sdwa v93, v93, v77 clamp dst_sel:DWORD dst_unused:UNUSED_PAD src0_sel:DWORD src1_sel:WORD_0
    v_mfma_f32_32x32x16_bf16 v[56:71], v[148:151], v[140:143], v[56:71]
    v_bfi_b32 v77, s57, v93, v77
    buffer_store_dword v76, v14, s[32:35], s65 offen offset:0 sc0 sc1
    buffer_store_dword v77, v14, s[32:35], s65 offen offset:1024 sc0 sc1
    v_mul_f32 v94, s55, v94
    s_waitcnt lgkmcnt(4)
    v_mfma_f32_32x32x16_bf16 v[40:55], v[152:155], v[184:187], v[40:55]
    ds_read_b64_tr_b16 v[136:137], v178 offset:49152
    ds_read_b64_tr_b16 v[138:139], v178 offset:50176
    ds_read_b64_tr_b16 v[140:141], v179 offset:49152
    ds_read_b64_tr_b16 v[142:143], v179 offset:50176
    v_cvt_pk_bf16_f32 v78, v78, v94
    v_and_b32 v94, 0x7fffffff, v94
    v_add_u32 v94, 0x8000, v94
    v_sub_u32_sdwa v94, v94, v78 clamp dst_sel:DWORD dst_unused:UNUSED_PAD src0_sel:DWORD src1_sel:WORD_0
    v_mfma_f32_32x32x16_bf16 v[56:71], v[152:155], v[188:191], v[56:71]
    v_bfi_b32 v78, s57, v94, v78
    v_mul_f32 v95, s55, v95
    v_cvt_pk_bf16_f32 v79, v79, v95
    v_and_b32 v95, 0x7fffffff, v95
    s_waitcnt lgkmcnt(4)
    v_mfma_f32_32x32x16_bf16 v[40:55], v[156:159], v[128:131], v[40:55]
    ds_read_b64_tr_b16 v[184:185], v178 offset:53248
    ds_read_b64_tr_b16 v[186:187], v178 offset:54272
    ds_read_b64_tr_b16 v[188:189], v179 offset:53248
    ds_read_b64_tr_b16 v[190:191], v179 offset:54272
    v_add_u32 v95, 0x8000, v95
    v_sub_u32_sdwa v95, v95, v79 clamp dst_sel:DWORD dst_unused:UNUSED_PAD src0_sel:DWORD src1_sel:WORD_0
    v_bfi_b32 v79, s57, v95, v79
    buffer_store_dword v78, v14, s[32:35], s65 offen offset:2048 sc0 sc1
    buffer_store_dword v79, v14, s[32:35], s65 offen offset:3072 sc0 sc1
    v_mfma_f32_32x32x16_bf16 v[56:71], v[156:159], v[132:135], v[56:71]
    v_mul_f32 v96, s55, v96
    v_cvt_pk_bf16_f32 v80, v80, v96
    v_and_b32 v96, 0x7fffffff, v96
    s_waitcnt lgkmcnt(4)
    v_mfma_f32_32x32x16_bf16 v[40:55], v[160:163], v[136:139], v[40:55]
    ds_read_b64_tr_b16 v[128:129], v178 offset:57344
    ds_read_b64_tr_b16 v[130:131], v178 offset:58368
    ds_read_b64_tr_b16 v[132:133], v179 offset:57344
    ds_read_b64_tr_b16 v[134:135], v179 offset:58368
    v_add_u32 v96, 0x8000, v96
    v_sub_u32_sdwa v96, v96, v80 clamp dst_sel:DWORD dst_unused:UNUSED_PAD src0_sel:DWORD src1_sel:WORD_0
    v_bfi_b32 v80, s57, v96, v80
    v_mul_f32 v97, s55, v97
    v_mfma_f32_32x32x16_bf16 v[56:71], v[160:163], v[140:143], v[56:71]
    v_cvt_pk_bf16_f32 v81, v81, v97
    v_and_b32 v97, 0x7fffffff, v97
    v_add_u32 v97, 0x8000, v97
    v_sub_u32_sdwa v97, v97, v81 clamp dst_sel:DWORD dst_unused:UNUSED_PAD src0_sel:DWORD src1_sel:WORD_0
    s_waitcnt lgkmcnt(4)
    v_mfma_f32_32x32x16_bf16 v[40:55], v[164:167], v[184:187], v[40:55]
    ds_read_b64_tr_b16 v[136:137], v178 offset:61440
    ds_read_b64_tr_b16 v[138:139], v178 offset:62464
    ds_read_b64_tr_b16 v[140:141], v179 offset:61440
    ds_read_b64_tr_b16 v[142:143], v179 offset:62464
    v_bfi_b32 v81, s57, v97, v81
    buffer_store_dword v80, v14, s[32:35], s66 offen offset:0 sc0 sc1
    buffer_store_dword v81, v14, s[32:35], s66 offen offset:1024 sc0 sc1
    v_mul_f32 v98, s55, v98
    v_mfma_f32_32x32x16_bf16 v[56:71], v[164:167], v[188:191], v[56:71]
    v_cvt_pk_bf16_f32 v82, v82, v98
    v_and_b32 v98, 0x7fffffff, v98
    v_add_u32 v98, 0x8000, v98
    v_sub_u32_sdwa v98, v98, v82 clamp dst_sel:DWORD dst_unused:UNUSED_PAD src0_sel:DWORD src1_sel:WORD_0
    s_waitcnt lgkmcnt(4)
    v_mfma_f32_32x32x16_bf16 v[40:55], v[168:171], v[128:131], v[40:55]
    v_bfi_b32 v82, s57, v98, v82
    v_mul_f32 v99, s55, v99
    v_cvt_pk_bf16_f32 v83, v83, v99
    v_and_b32 v99, 0x7fffffff, v99
    v_mfma_f32_32x32x16_bf16 v[56:71], v[168:171], v[132:135], v[56:71]
    v_add_u32 v99, 0x8000, v99
    v_sub_u32_sdwa v99, v99, v83 clamp dst_sel:DWORD dst_unused:UNUSED_PAD src0_sel:DWORD src1_sel:WORD_0
    v_bfi_b32 v83, s57, v99, v83
    buffer_store_dword v82, v14, s[32:35], s66 offen offset:2048 sc0 sc1
    buffer_store_dword v83, v14, s[32:35], s66 offen offset:3072 sc0 sc1
    s_waitcnt lgkmcnt(0)
    v_mfma_f32_32x32x16_bf16 v[40:55], v[172:175], v[136:139], v[40:55]
    v_mul_f32 v100, s55, v100
    v_cvt_pk_bf16_f32 v84, v84, v100
    v_and_b32 v100, 0x7fffffff, v100
    v_mfma_f32_32x32x16_bf16 v[56:71], v[172:175], v[140:143], v[56:71]
    v_add_u32 v100, 0x8000, v100
    v_sub_u32_sdwa v100, v100, v84 clamp dst_sel:DWORD dst_unused:UNUSED_PAD src0_sel:DWORD src1_sel:WORD_0
    v_bfi_b32 v84, s57, v100, v84
    buffer_store_dword v84, v14, s[32:35], s67 offen offset:0 sc0 sc1
    s_waitcnt vmcnt(9)
    s_branch K_HAVER
K_NOA:
    s_waitcnt vmcnt(0)
K_HAVER:
    v_lshlrev_b32 v204, 2, v218
    v_and_b32 v204, 60, v204
    v_lshlrev_b32 v205, 2, v222
    v_and_b32 v205, 60, v205
    v_lshlrev_b32 v206, 2, v226
    v_and_b32 v206, 60, v206
    v_lshlrev_b32 v207, 2, v230
    v_and_b32 v207, 60, v207
    s_mov_b64 exec, s[76:77]
    ds_add_rtn_u32 v200, v204, v17 offset:896
    s_mov_b64 exec, s[78:79]
    ds_add_rtn_u32 v201, v205, v17 offset:896
    s_mov_b64 exec, s[80:81]
    ds_add_rtn_u32 v202, v206, v17 offset:896
    s_mov_b64 exec, s[82:83]
    ds_add_rtn_u32 v203, v207, v17 offset:896
    s_mov_b64 exec, -1
    v_lshrrev_b32 v240, 8, v218
    v_mul_u32_u24 v240, 6, v240
    v_and_b32 v240, -4, v240
    v_lshrrev_b32 v241, 8, v222
    v_mul_u32_u24 v241, 6, v241
    v_and_b32 v241, -4, v241
    v_lshrrev_b32 v242, 8, v226
    v_mul_u32_u24 v242, 6, v242
    v_and_b32 v242, -4, v242
    v_lshrrev_b32 v243, 8, v230
    v_mul_u32_u24 v243, 6, v243
    v_and_b32 v243, -4, v243
    s_lshl_b32 s55, s2, 6
    s_add_u32 s55, s55, 12713984
    v_lshl_add_u32 v232, v1, 3, s55
    v_mov_b32 v234, s71
    v_not_b32 v235, s71
    s_waitcnt vmcnt(0) lgkmcnt(0)
    s_barrier
    s_cmp_lg_u32 s52, 0
    s_cbranch_scc1 K_NOFB
    s_mov_b64 exec, 0xff
    global_store_dwordx2 v232, v[234:235], s[22:23] sc0 sc1
    s_mov_b64 exec, -1
K_NOFB:
    buffer_load_dwordx2 v[192:193], v240, s[40:43], 0 offen
    buffer_load_dwordx2 v[194:195], v241, s[40:43], 0 offen
    s_cmp_eq_u32 s60, 0
    s_cbranch_scc1 K_GEMMH
    v_lshlrev_b32 v236, 2, v1
    v_and_b32 v236, 60, v236
    ds_read_b32 v236, v236 offset:896
    v_and_b32 v3, 3, v1
    v_mul_u32_u24 v3, 2560, v3
    v_mov_b32 v244, v3
    v_mov_b32 v245, v3
    s_waitcnt lgkmcnt(0)
    v_min_u32 v236, 640, v236
    v_max_u32 v237, 4, v236
    v_add_u32 v237, 124, v237
    v_add_u32 v238, v3, v236
    v_add_u32 v239, v3, v237
    v_and_b32 v239, 0xffffff80, v239
    v_mov_b32_dpp v244, v238 row_shr:4 row_mask:0xf bank_mask:0xe
    s_nop 0
    v_mov_b32_dpp v245, v239 row_shr:4 row_mask:0xf bank_mask:0xe
    v_add_u32 v246, v244, v236
    v_cmp_gt_u32 s[94:95], v246, v245
    s_nop 1
    v_cndmask_b32 v3, v245, v244, s[94:95]
    v_add_u32 v238, v3, v236
    v_add_u32 v239, v3, v237
    v_and_b32 v239, 0xffffff80, v239
    v_mov_b32_dpp v244, v238 row_shr:4 row_mask:0xf bank_mask:0xe
    s_nop 0
    v_mov_b32_dpp v245, v239 row_shr:4 row_mask:0xf bank_mask:0xe
    v_add_u32 v246, v244, v236
    v_cmp_gt_u32 s[94:95], v246, v245
    s_nop 1
    v_cndmask_b32 v3, v245, v244, s[94:95]
    v_add_u32 v238, v3, v236
    buffer_load_dwordx2 v[196:197], v242, s[40:43], 0 offen
    v_add_u32 v239, v3, v237
    v_and_b32 v239, 0xffffff80, v239
    v_mov_b32_dpp v244, v238 row_shr:4 row_mask:0xf bank_mask:0xe
    s_nop 0
    v_mov_b32_dpp v245, v239 row_shr:4 row_mask:0xf bank_mask:0xe
    v_add_u32 v246, v244, v236
    v_cmp_gt_u32 s[94:95], v246, v245
    s_nop 1
    v_cndmask_b32 v3, v245, v244, s[94:95]
    v_add_u32 v238, v3, v236
    v_add_u32 v239, v3, v237
    v_and_b32 v239, 0xffffff80, v239
    ds_bpermute_b32 v204, v204, v3
    ds_bpermute_b32 v205, v205, v3
    ds_bpermute_b32 v206, v206, v3
    ds_bpermute_b32 v207, v207, v3
    v_mov_b32 v246, v239
    v_subrev_u32 v237, 128, v239
    v_sub_u32 v238, v238, v237
    v_mov_b32_dpp v246, v3 row_shl:4 row_mask:0xf bank_mask:0x7
    v_cmp_lt_u32 s[94:95], v246, v239
    v_subrev_u32 v236, 4, v238
    v_ashrrev_i32 v236, 5, v236
    v_max_i32 v236, 0, v236
    v_mov_b32 v246, 128
    v_cndmask_b32 v236, v236, 8, s[94:95]
    v_cndmask_b32 v238, v238, v246, s[94:95]
    v_xor_b32 v13, 16, v236
    s_lshl_b32 s57, s54, 5
    s_lshl_b32 s56, s53, 2
    s_add_u32 s57, s57, s56
    v_add_u32 v246, s57, v18
    ds_bpermute_b32 v232, v246, v237
    ds_bpermute_b32 v233, v246, v238
    s_add_u32 s57, s53, 12
    v_readlane_b32 s73, v239, s57
    v_readlane_b32 s11, v3, s57
    s_mul_i32 s57, s53, 80
    v_lshrrev_b32 v3, 5, v237
    v_subrev_u32 v3, s57, v3
    v_min_u32 v3, 80, v3
    s_branch K_NOGEMM
K_GEMMH:
    ds_read_b64_tr_b16 v[128:129], v180 offset:28416
    ds_read_b64_tr_b16 v[130:131], v180 offset:29440
    ds_read_b64_tr_b16 v[132:133], v181 offset:28416
    ds_read_b64_tr_b16 v[134:135], v181 offset:29440
    ds_read_b64_tr_b16 v[136:137], v180 offset:32512
    ds_read_b64_tr_b16 v[138:139], v180 offset:33536
    ds_read_b64_tr_b16 v[140:141], v181 offset:32512
    ds_read_b64_tr_b16 v[142:143], v181 offset:33536
    s_waitcnt lgkmcnt(4)
    v_mfma_f32_32x32x16_bf16 v[72:87], v[144:147], v[128:131], 0
    ds_read_b64_tr_b16 v[184:185], v180 offset:36608
    ds_read_b64_tr_b16 v[186:187], v180 offset:37632
    ds_read_b64_tr_b16 v[188:189], v181 offset:36608
    ds_read_b64_tr_b16 v[190:191], v181 offset:37632
    v_lshlrev_b32 v236, 2, v1
    v_and_b32 v236, 60, v236
    ds_read_b32 v236, v236 offset:896
    s_mov_b32 s100, 0x10801080
    s_mov_b32 s101, 0x10801080
    v_lshl_add_u64 v[210:211], v[210:211], 0, s[100:101]
    v_lshl_add_u64 v[212:213], v[212:213], 0, s[100:101]
    ds_write_b128 v183, v[210:213] offset:32768
    ds_read_b64_tr_b16 v[122:123], v182 offset:0
    ds_read_b64_tr_b16 v[126:127], v182 offset:64
    v_mfma_f32_32x32x16_bf16 v[88:103], v[144:147], v[132:135], 0
    v_and_b32 v3, 3, v1
    s_mov_b32 s55, 0x3fb8aa3b
    v_mul_u32_u24 v3, 2560, v3
    v_mul_f32 v56, s55, v56
    v_mov_b32 v244, v3
    v_mul_f32 v57, s55, v57
    v_mov_b32 v245, v3
    s_waitcnt lgkmcnt(3)
    v_min_u32 v236, 640, v236
    v_mul_f32 v58, s55, v58
    v_mfma_f32_32x32x16_bf16 v[72:87], v[148:151], v[136:139], v[72:87]
    ds_read_b64_tr_b16 v[128:129], v180 offset:40704
    ds_read_b64_tr_b16 v[130:131], v180 offset:41728
    ds_read_b64_tr_b16 v[132:133], v181 offset:40704
    ds_read_b64_tr_b16 v[134:135], v181 offset:41728
    v_max_u32 v237, 4, v236
    v_mul_f32 v59, s55, v59
    v_add_u32 v237, 124, v237
    s_mov_b32 s100, 0x10001000
    s_mov_b32 s101, 0x10001000
    v_lshl_add_u64 v[210:211], v[210:211], 0, s[100:101]
    v_lshl_add_u64 v[212:213], v[212:213], 0, s[100:101]
    ds_write_b128 v183, v[210:213] offset:40960
    v_mul_f32 v60, s55, v60
    v_add_u32 v238, v3, v236
    v_mfma_f32_32x32x16_bf16 v[88:103], v[148:151], v[140:143], v[88:103]
    v_add_u32 v239, v3, v237
    v_mul_f32 v61, s55, v61
    v_and_b32 v239, 0xffffff80, v239
    v_mul_f32 v62, s55, v62
    v_mov_b32_dpp v244, v238 row_shr:4 row_mask:0xf bank_mask:0xe
    v_mul_f32 v63, s55, v63
    s_nop 0
    v_mov_b32_dpp v245, v239 row_shr:4 row_mask:0xf bank_mask:0xe
    v_mul_f32 v64, s55, v64
    v_mfma_f32_32x32x16_bf16 v[72:87], v[152:155], v[184:187], v[72:87]
    ds_read_b64_tr_b16 v[136:137], v180 offset:44800
    ds_read_b64_tr_b16 v[138:139], v180 offset:45824
    ds_read_b64_tr_b16 v[140:141], v181 offset:44800
    ds_read_b64_tr_b16 v[142:143], v181 offset:45824
    v_add_u32 v246, v244, v236
    v_mul_f32 v65, s55, v65
    v_lshl_add_u64 v[210:211], v[210:211], 0, s[100:101]
    v_lshl_add_u64 v[212:213], v[212:213], 0, s[100:101]
    ds_write_b128 v183, v[210:213] offset:49152
    v_cmp_gt_u32 s[94:95], v246, v245
    v_mul_f32 v66, s55, v66
    s_nop 1
    v_cndmask_b32 v3, v245, v244, s[94:95]
    v_mul_f32 v67, s55, v67
    v_mfma_f32_32x32x16_bf16 v[88:103], v[152:155], v[188:191], v[88:103]
    v_add_u32 v238, v3, v236
    v_mul_f32 v68, s55, v68
    v_add_u32 v239, v3, v237
    v_cvt_pk_bf16_f32 v104, v40, v44
    v_and_b32 v239, 0xffffff80, v239
    v_cvt_pk_bf16_f32 v105, v48, v52
    v_mov_b32_dpp v244, v238 row_shr:4 row_mask:0xf bank_mask:0xe
    s_nop 0
    v_lshl_add_u64 v[210:211], v[210:211], 0, s[100:101]
    v_lshl_add_u64 v[212:213], v[212:213], 0, s[100:101]
    ds_write_b128 v183, v[210:213] offset:57344
    s_waitcnt lgkmcnt(7)
    v_mfma_f32_32x32x16_bf16 v[72:87], v[156:159], v[128:131], v[72:87]
    ds_read_b64_tr_b16 v[184:185], v180 offset:48896
    ds_read_b64_tr_b16 v[186:187], v180 offset:49920
    ds_read_b64_tr_b16 v[188:189], v181 offset:48896
    ds_read_b64_tr_b16 v[190:191], v181 offset:49920
    v_cvt_pk_bf16_f32 v106, v56, v60
    v_mov_b32_dpp v245, v239 row_shr:4 row_mask:0xf bank_mask:0xe
    v_cvt_pk_bf16_f32 v107, v64, v68
    v_add_u32 v246, v244, v236
    v_cvt_pk_bf16_f32 v108, v41, v45
    v_cmp_gt_u32 s[94:95], v246, v245
    s_nop 1
    v_cvt_pk_bf16_f32 v109, v49, v53
    v_cndmask_b32 v3, v245, v244, s[94:95]
    v_mfma_f32_32x32x16_bf16 v[88:103], v[156:159], v[132:135], v[88:103]
    v_cvt_pk_bf16_f32 v110, v57, v61
    v_add_u32 v238, v3, v236
    v_cvt_pk_bf16_f32 v111, v65, v69
    buffer_load_dwordx2 v[196:197], v242, s[40:43], 0 offen
    s_mov_b32 s100, 0xf800f80
    s_mov_b32 s101, 0xf800f80
    v_lshl_add_u64 v[210:211], v[210:211], 0, s[100:101]
    v_lshl_add_u64 v[212:213], v[212:213], 0, s[100:101]
    v_add_u32 v183, 65536, v183
    ds_write_b128 v183, v[210:213] offset:0
    s_waitcnt lgkmcnt(7)
    v_mfma_f32_32x32x16_bf16 v[72:87], v[160:163], v[136:139], v[72:87]
    ds_read_b64_tr_b16 v[128:129], v180 offset:52992
    ds_read_b64_tr_b16 v[130:131], v180 offset:54016
    ds_read_b64_tr_b16 v[132:133], v181 offset:52992
    ds_read_b64_tr_b16 v[134:135], v181 offset:54016
    v_add_u32 v239, v3, v237
    v_cvt_pk_bf16_f32 v112, v42, v46
    v_and_b32 v239, 0xffffff80, v239
    v_cvt_pk_bf16_f32 v113, v50, v54
    v_mov_b32_dpp v244, v238 row_shr:4 row_mask:0xf bank_mask:0xe
    v_cvt_pk_bf16_f32 v114, v58, v62
    s_nop 0
    v_mov_b32_dpp v245, v239 row_shr:4 row_mask:0xf bank_mask:0xe
    v_cvt_pk_bf16_f32 v115, v66, v70
    v_mfma_f32_32x32x16_bf16 v[88:103], v[160:163], v[140:143], v[88:103]
    v_add_u32 v246, v244, v236
    v_cvt_pk_bf16_f32 v116, v43, v47
    v_cmp_gt_u32 s[94:95], v246, v245
    v_cvt_pk_bf16_f32 v117, v51, v55
    s_mov_b32 s100, 0x10001000
    s_mov_b32 s101, 0x10001000
    v_lshl_add_u64 v[210:211], v[210:211], 0, s[100:101]
    v_lshl_add_u64 v[212:213], v[212:213], 0, s[100:101]
    ds_write_b128 v183, v[210:213] offset:8192
    s_nop 1
    s_waitcnt lgkmcnt(6)
    v_mfma_f32_32x32x16_bf16 v[72:87], v[164:167], v[184:187], v[72:87]
    ds_read_b64_tr_b16 v[136:137], v180 offset:57088
    ds_read_b64_tr_b16 v[138:139], v180 offset:58112
    ds_read_b64_tr_b16 v[140:141], v181 offset:57088
    ds_read_b64_tr_b16 v[142:143], v181 offset:58112
    v_cndmask_b32 v3, v245, v244, s[94:95]
    v_cvt_pk_bf16_f32 v118, v59, v63
    v_add_u32 v238, v3, v236
    v_cvt_pk_bf16_f32 v119, v67, v71
    v_add_u32 v239, v3, v237
    v_and_b32 v239, 0xffffff80, v239
    v_lshlrev_b32 v234, 16, v126
    ds_bpermute_b32 v204, v204, v3
    ds_bpermute_b32 v205, v205, v3
    ds_bpermute_b32 v206, v206, v3
    ds_bpermute_b32 v207, v207, v3
    v_mfma_f32_32x32x16_bf16 v[88:103], v[164:167], v[188:191], v[88:103]
    v_mov_b32 v246, v239
    v_and_b32 v235, 0xffff0000, v126
    v_subrev_u32 v237, 128, v239
    v_lshl_add_u64 v[210:211], v[210:211], 0, s[100:101]
    v_lshl_add_u64 v[212:213], v[212:213], 0, s[100:101]
    ds_write_b128 v183, v[210:213] offset:16384
    v_mul_f32 v234, s55, v234
    s_waitcnt lgkmcnt(10)
    v_mfma_f32_32x32x16_bf16 v[72:87], v[168:171], v[128:131], v[72:87]
    v_sub_u32 v238, v238, v237
    v_mul_f32 v235, s55, v235
    v_mov_b32_dpp v246, v3 row_shl:4 row_mask:0xf bank_mask:0x7
    v_cmp_lt_u32 s[94:95], v246, v239
    v_cvt_pk_bf16_f32 v126, v234, v235
    v_subrev_u32 v236, 4, v238
    v_lshlrev_b32 v234, 16, v127
    v_ashrrev_i32 v236, 5, v236
    v_and_b32 v235, 0xffff0000, v127
    v_max_i32 v236, 0, v236
    v_mfma_f32_32x32x16_bf16 v[88:103], v[168:171], v[132:135], v[88:103]
    v_mov_b32 v246, 128
    v_mul_f32 v234, s55, v234
    v_lshl_add_u64 v[210:211], v[210:211], 0, s[100:101]
    v_lshl_add_u64 v[212:213], v[212:213], 0, s[100:101]
    ds_write_b128 v183, v[210:213] offset:24576
    v_cndmask_b32 v236, v236, 8, s[94:95]
    v_mul_f32 v235, s55, v235
    v_cndmask_b32 v238, v238, v246, s[94:95]
    v_cvt_pk_bf16_f32 v127, v234, v235
    v_xor_b32 v13, 16, v236
    s_waitcnt lgkmcnt(6)
    v_mfma_f32_32x32x16_bf16 v[72:87], v[172:175], v[136:139], v[72:87]
    s_lshl_b32 s57, s54, 5
    s_lshl_b32 s56, s53, 2
    s_add_u32 s57, s57, s56
    v_add_u32 v246, s57, v18
    s_mov_b32 exec_lo, 0
    v_sub_f32 v234, v235, v127
    v_cvt_pk_bf16_f32 v127, v234, v127
    s_mov_b32 exec_lo, -1
    ds_bpermute_b32 v232, v246, v237
    ds_bpermute_b32 v233, v246, v238
    v_mfma_f32_32x32x16_bf16 v[88:103], v[172:175], v[140:143], v[88:103]
    v_lshrrev_b32 v234, 3, v8
    s_add_u32 s57, s53, 12
    v_readlane_b32 s73, v239, s57
    v_readlane_b32 s11, v3, s57
    v_sub_u32 v14, v14, v234
    s_mul_i32 s57, s53, 80
    v_lshrrev_b32 v3, 5, v237
    v_subrev_u32 v3, s57, v3
    v_min_u32 v3, 80, v3
K_NOGEMM:
    s_or_b32 s57, s52, s60
    s_cmp_gt_u32 s57, 3
    s_cbranch_scc1 K_NOPB
    global_load_dwordx2 v[208:209], v214, s[22:23] sc1
K_NOPB:
    buffer_load_dwordx2 v[198:199], v243, s[40:43], 0 offen
    s_movk_i32 s55, 640
    s_mov_b64 s[94:95], 0
    s_waitcnt lgkmcnt(0)
    ds_permute_b32 v13, v3, v13
    v_cmp_gt_u32 vcc, s55, v200
    v_add_u32 v200, v200, v204
    v_and_b32 v176, 124, v200
    v_lshrrev_b32 v204, 7, v200
    v_mul_u32_u24 v204, 768, v204
    s_andn2_b64 s[8:9], s[76:77], vcc
    s_or_b64 s[94:95], s[94:95], s[8:9]
    s_and_b64 s[76:77], s[76:77], vcc
    v_add_u32 v244, v176, v204
    v_and_b32 v200, 16, v200
    v_and_b32 v235, 0xffffff80, v218
    v_mad_i32_i24 v200, v200, -8, v235
    v_cmp_gt_u32 vcc, s55, v201
    v_add_u32 v201, v201, v205
    v_and_b32 v177, 124, v201
    v_lshrrev_b32 v205, 7, v201
    v_mul_u32_u24 v205, 768, v205
    s_andn2_b64 s[8:9], s[78:79], vcc
    s_or_b64 s[94:95], s[94:95], s[8:9]
    s_and_b64 s[78:79], s[78:79], vcc
    v_add_u32 v245, v177, v205
    v_and_b32 v201, 16, v201
    v_and_b32 v235, 0xffffff80, v222
    v_mad_i32_i24 v201, v201, -8, v235
    v_cmp_gt_u32 vcc, s55, v202
    v_add_u32 v202, v202, v206
    v_and_b32 v178, 124, v202
    v_lshrrev_b32 v206, 7, v202
    v_mul_u32_u24 v206, 768, v206
    s_andn2_b64 s[8:9], s[80:81], vcc
    s_or_b64 s[94:95], s[94:95], s[8:9]
    s_and_b64 s[80:81], s[80:81], vcc
    v_add_u32 v246, v178, v206
    v_and_b32 v202, 16, v202
    v_and_b32 v235, 0xffffff80, v226
    v_mad_i32_i24 v202, v202, -8, v235
    v_cmp_gt_u32 vcc, s55, v203
    v_add_u32 v203, v203, v207
    v_and_b32 v179, 124, v203
    v_lshrrev_b32 v207, 7, v203
    v_mul_u32_u24 v207, 768, v207
    s_andn2_b64 s[8:9], s[82:83], vcc
    s_or_b64 s[94:95], s[94:95], s[8:9]
    s_and_b64 s[82:83], s[82:83], vcc
    v_add_u32 v247, v179, v207
    v_and_b32 v203, 16, v203
    v_and_b32 v235, 0xffffff80, v230
    v_mad_i32_i24 v203, v203, -8, v235
    v_mul_u32_u24 v237, 6, v232
    v_lshrrev_b32 v238, 2, v8
    v_cmp_ge_u32 vcc, v238, v233
    v_add_u32 v238, v238, v237
    v_add_u32 v239, v6, v237
    v_add_u32 v237, v8, v237
    s_barrier
    s_mov_b64 exec, vcc
    ds_write_b32 v238, v248 offset:3328
    ds_write_b32 v239, v248 offset:2816
    ds_write_b128 v237, v[248:251] offset:2816
    s_mov_b64 exec, s[76:77]
    ds_write_b32 v244, v200 offset:3328
    s_mov_b64 exec, s[78:79]
    ds_write_b32 v245, v201 offset:3328
    s_mov_b64 exec, s[80:81]
    ds_write_b32 v246, v202 offset:3328
    s_mov_b64 exec, s[82:83]
    ds_write_b32 v247, v203 offset:3328
    s_mov_b64 exec, -1
    s_cmp_eq_u64 s[94:95], 0
    s_cbranch_scc1 K_NOPEND
    ds_write_b32 v248, v17 offset:960
K_NOPEND:
    s_add_u32 s55, s58, 256
    s_cmp_le_u32 s59, s55
    s_cbranch_scc1 K_NOMORE
    ds_write_b32 v248, v17 offset:964
K_NOMORE:
    v_add_u32 v4, s64, v11
    s_cmp_lg_u32 s60, 0
    s_cbranch_scc1 K_NOH1
    v_and_b32 v235, 0x180, v0
    v_add_lshl_u32 v234, v0, v235, 4
    v_mov_b32 v235, 0
    v_lshl_add_u64 v[234:235], v[234:235], 0, s[96:97]
    s_mov_b32 s100, 0x1e1d1c00
    s_mov_b32 s101, 0x403f201f
    s_lshl_b32 s55, s52, 3
    s_lshr_b64 s[100:101], s[100:101], s55
    s_and_b32 s55, s100, 0xff
    s_lshl_b32 s55, s55, 10
    s_add_u32 m0, s55, 64256
    s_nop 0
    global_load_lds_dwordx4 v[234:235], off offset:0
    s_mov_b32 s100, 0x5f5e5d5c
    s_mov_b32 s101, 0x5b1b6160
    s_lshl_b32 s55, s52, 3
    s_lshr_b64 s[100:101], s[100:101], s55
    s_and_b32 s55, s100, 0xff
    s_lshl_b32 s55, s55, 10
    s_add_u32 m0, s55, 62208
    s_nop 0
    global_load_lds_dwordx4 v[234:235], off offset:2048
K_NOH1:
    s_waitcnt lgkmcnt(0)
    s_or_b32 s57, s52, s60
    s_cmp_gt_u32 s57, 3
    s_cbranch_scc1 K_HAVEB
    s_mov_b32 s57, 0
    s_waitcnt vmcnt(3)
K_POLLB:
    v_xor_b32 v232, s71, v208
    v_xnor_b32 v233, s71, v209
    v_or_b32 v232, v232, v233
    v_cmp_ne_u32 vcc, 0, v232
    s_add_u32 s57, s57, 1
    s_cbranch_vccz K_HAVEB
    s_cmp_gt_u32 s57, 400000
    s_cbranch_scc1 K_END
    s_mov_b64 exec, vcc
    global_load_dwordx2 v[208:209], v214, s[22:23] sc1
    s_waitcnt vmcnt(0)
    s_branch K_POLLB
K_HAVEB:
    s_mov_b64 exec, -1
    s_barrier
    ds_read_b128 v[144:147], v4 offset:0
    ds_read_b128 v[148:151], v4 offset:32
    ds_read_b128 v[152:155], v4 offset:64
    ds_read_b128 v[156:159], v4 offset:96
    ds_read_b128 v[160:163], v4 offset:768
    ds_read_b128 v[164:167], v4 offset:800
    ds_read_b128 v[168:171], v4 offset:832
    ds_read_b128 v[172:175], v4 offset:864
    ds_read_b64 v[246:247], v248 offset:960
    s_waitcnt lgkmcnt(5)
    buffer_load_dword v144, v144, s[4:7], 0 offen
    buffer_load_dword v145, v145, s[4:7], 0 offen
    buffer_load_dword v146, v146, s[4:7], 0 offen
    buffer_load_dword v147, v147, s[4:7], 0 offen
    buffer_load_dword v148, v148, s[4:7], 0 offen
    buffer_load_dword v149, v149, s[4:7], 0 offen
    buffer_load_dword v150, v150, s[4:7], 0 offen
    buffer_load_dword v151, v151, s[4:7], 0 offen
    buffer_load_dword v152, v152, s[4:7], 0 offen
    buffer_load_dword v153, v153, s[4:7], 0 offen
    buffer_load_dword v154, v154, s[4:7], 0 offen
    buffer_load_dword v155, v155, s[4:7], 0 offen
    buffer_load_dword v156, v156, s[4:7], 0 offen
    buffer_load_dword v157, v157, s[4:7], 0 offen
    buffer_load_dword v158, v158, s[4:7], 0 offen
    buffer_load_dword v159, v159, s[4:7], 0 offen
    s_mul_i32 s57, s53, 2560
    s_sub_u32 s55, s73, s57
    s_lshr_b32 s55, s55, 7
    s_sub_u32 s11, s11, s57
    s_cmp_ge_u32 s11, 768
    s_cselect_b32 s11, 12, 16
    s_cmp_le_u32 s55, 14
    s_cselect_b32 s11, s11, 16
    v_xor_b32 v233, 16, v13
    v_mul_u32_u24 v234, 768, v1
    v_add3_u32 v233, v233, v234, s64
    s_waitcnt lgkmcnt(0)
    v_lshlrev_b32_sdwa v236, 4, v218 dst_sel:DWORD dst_unused:UNUSED_PAD src0_sel:DWORD src1_sel:BYTE_0
    ds_bpermute_b32 v180, v176, v6
    v_add_u32 v236, -1152, v236
    ds_read_b128 v[128:131], v236
    v_lshl_add_u32 v176, v176, 2, v204
    s_or_b64 s[84:85], s[84:85], s[76:77]
    v_lshlrev_b32_sdwa v237, 4, v222 dst_sel:DWORD dst_unused:UNUSED_PAD src0_sel:DWORD src1_sel:BYTE_0
    ds_bpermute_b32 v181, v177, v6
    v_add_u32 v237, -1152, v237
    ds_read_b128 v[132:135], v237
    v_lshl_add_u32 v177, v177, 2, v205
    s_or_b64 s[86:87], s[86:87], s[78:79]
    v_lshlrev_b32_sdwa v238, 4, v226 dst_sel:DWORD dst_unused:UNUSED_PAD src0_sel:DWORD src1_sel:BYTE_0
    ds_bpermute_b32 v182, v178, v6
    v_add_u32 v238, -1152, v238
    ds_read_b128 v[136:139], v238
    v_lshl_add_u32 v178, v178, 2, v206
    s_or_b64 s[88:89], s[88:89], s[80:81]
    v_lshlrev_b32_sdwa v239, 4, v230 dst_sel:DWORD dst_unused:UNUSED_PAD src0_sel:DWORD src1_sel:BYTE_0
    ds_bpermute_b32 v183, v179, v6
    v_add_u32 v239, -1152, v239
    ds_read_b128 v[140:143], v239
    v_lshl_add_u32 v179, v179, 2, v207
    s_or_b64 s[90:91], s[90:91], s[82:83]
    v_and_b32 v235, 1, v1
    v_lshlrev_b32 v235, 8, v235
    v_add_u32 v235, 256, v235
    v_cmp_gt_u32 s[94:95], s55, v1
    s_nop 1
    v_cndmask_b32 v233, v235, v233, s[94:95]
    s_mov_b32 s62, 0
    s_mov_b32 s61, 0
    v_mov_b32_dpp v13, v233 wave_shl:1 row_mask:0xf bank_mask:0xf
    v_readlane_b32 s63, v233, 0
    s_mov_b32 s92, 0x11111111
    v_mov_b32_dpp v236, v13 wave_shl:1 row_mask:0xf bank_mask:0xf
    v_and_b32 v236, 0xff00, v236
    v_lshl_or_b32 v13, v236, 16, v13
    s_mov_b32 s93, 0x11111111
    s_waitcnt vmcnt(16)
    s_cmp_lg_u32 s60, 0
    s_cbranch_scc1 K_NOZS
    s_mov_b32 s94, 0x3fb8aa3b
    v_pk_mul_f32 v[72:73], v[72:73], s[94:95] op_sel_hi:[1,0]
    v_pk_mul_f32 v[74:75], v[74:75], s[94:95] op_sel_hi:[1,0]
    v_pk_mul_f32 v[76:77], v[76:77], s[94:95] op_sel_hi:[1,0]
    v_pk_mul_f32 v[78:79], v[78:79], s[94:95] op_sel_hi:[1,0]
    v_pk_mul_f32 v[80:81], v[80:81], s[94:95] op_sel_hi:[1,0]
    v_pk_mul_f32 v[82:83], v[82:83], s[94:95] op_sel_hi:[1,0]
    v_pk_mul_f32 v[84:85], v[84:85], s[94:95] op_sel_hi:[1,0]
    v_pk_mul_f32 v[88:89], v[88:89], s[94:95] op_sel_hi:[1,0]
    v_pk_mul_f32 v[90:91], v[90:91], s[94:95] op_sel_hi:[1,0]
    v_pk_mul_f32 v[92:93], v[92:93], s[94:95] op_sel_hi:[1,0]
    v_pk_mul_f32 v[94:95], v[94:95], s[94:95] op_sel_hi:[1,0]
    v_pk_mul_f32 v[96:97], v[96:97], s[94:95] op_sel_hi:[1,0]
    v_pk_mul_f32 v[98:99], v[98:99], s[94:95] op_sel_hi:[1,0]
    v_pk_mul_f32 v[100:101], v[100:101], s[94:95] op_sel_hi:[1,0]
K_NOZS:
    v_mov_b64 v[120:121], v[104:105]
    v_mov_b64 v[124:125], v[106:107]
    v_mfma_f32_32x32x16_bf16 v[40:55], v[248:251], v[248:251], 0
    v_mfma_f32_32x32x16_bf16 v[56:71], v[248:251], v[248:251], 0
    s_waitcnt lgkmcnt(0)
    v_add_u32 v180, v180, v204
    v_add_u32 v181, v181, v205
    v_add_u32 v182, v182, v206
    v_add_u32 v183, v183, v207
    v_readfirstlane_b32 s68, v246
    v_readfirstlane_b32 s69, v247
    s_mov_b32 s55, 0xbf80
    v_lshrrev_b32 v232, 4, v218
    v_and_b32 v232, 16, v232
    v_lshlrev_b32_e64 v232, v232, s55
    v_alignbit_b32 v233, v193, v192, 16
    v_dot2_f32_bf16 v128, v192, v232, v128
    v_dot2_f32_bf16 v129, v233, v232, v129
    v_dot2_f32_bf16 v130, v193, v232, v130
    v_xor_b32 v235, 0x04040404, v131
    v_cvt_pk_bf16_f32 v236, 0, v128
    s_nop 0
    v_cvt_pk_bf16_f32 v237, v129, v130
    v_dot2_f32_bf16 v238, v236, v236, 0
    v_dot2_f32_bf16 v238, v237, v237, v238
    v_or_b32 v236, 0x3f80, v236
    v_perm_b32 v219, v237, v236, v235
    v_and_b32 v239, 0x74, v218
    v_cvt_pk_bf16_f32 v238, 0, v238
    v_lshl_or_b32 v238, v239, 1, v238
    v_perm_b32 v218, v237, v236, v131
    s_mov_b64 exec, s[76:77]
    ds_write_b128 v176, v[216:219] offset:2816
    ds_write_b32 v180, v238 offset:2816
    s_mov_b64 exec, -1
    v_lshrrev_b32 v232, 4, v222
    v_and_b32 v232, 16, v232
    v_lshlrev_b32_e64 v232, v232, s55
    v_alignbit_b32 v233, v195, v194, 16
    v_dot2_f32_bf16 v132, v194, v232, v132
    v_dot2_f32_bf16 v133, v233, v232, v133
    v_dot2_f32_bf16 v134, v195, v232, v134
    v_xor_b32 v235, 0x04040404, v135
    v_cvt_pk_bf16_f32 v236, 0, v132
    s_nop 0
    v_cvt_pk_bf16_f32 v237, v133, v134
    v_dot2_f32_bf16 v238, v236, v236, 0
    v_dot2_f32_bf16 v238, v237, v237, v238
    v_or_b32 v236, 0x3f80, v236
    v_perm_b32 v223, v237, v236, v235
    v_and_b32 v239, 0x74, v222
    v_cvt_pk_bf16_f32 v238, 0, v238
    v_lshl_or_b32 v238, v239, 1, v238
    v_perm_b32 v222, v237, v236, v135
    s_mov_b64 exec, s[78:79]
    ds_write_b128 v177, v[220:223] offset:2816
    ds_write_b32 v181, v238 offset:2816
    s_mov_b64 exec, -1
    v_lshrrev_b32 v232, 4, v226
    v_and_b32 v232, 16, v232
    v_lshlrev_b32_e64 v232, v232, s55
    v_alignbit_b32 v233, v197, v196, 16
    v_dot2_f32_bf16 v136, v196, v232, v136
    v_dot2_f32_bf16 v137, v233, v232, v137
    v_dot2_f32_bf16 v138, v197, v232, v138
    v_xor_b32 v235, 0x04040404, v139
    v_cvt_pk_bf16_f32 v236, 0, v136
    s_nop 0
    v_cvt_pk_bf16_f32 v237, v137, v138
    v_dot2_f32_bf16 v238, v236, v236, 0
    v_dot2_f32_bf16 v238, v237, v237, v238
    v_or_b32 v236, 0x3f80, v236
    v_perm_b32 v227, v237, v236, v235
    v_and_b32 v239, 0x74, v226
    v_cvt_pk_bf16_f32 v238, 0, v238
    v_lshl_or_b32 v238, v239, 1, v238
    v_perm_b32 v226, v237, v236, v139
    s_mov_b64 exec, s[80:81]
    ds_write_b128 v178, v[224:227] offset:2816
    ds_write_b32 v182, v238 offset:2816
    s_mov_b64 exec, -1
    v_lshrrev_b32 v232, 4, v230
    v_and_b32 v232, 16, v232
    v_lshlrev_b32_e64 v232, v232, s55
    v_alignbit_b32 v233, v199, v198, 16
    v_dot2_f32_bf16 v140, v198, v232, v140
    v_dot2_f32_bf16 v141, v233, v232, v141
    v_dot2_f32_bf16 v142, v199, v232, v142
    v_xor_b32 v235, 0x04040404, v143
    v_cvt_pk_bf16_f32 v236, 0, v140
    s_nop 0
    v_cvt_pk_bf16_f32 v237, v141, v142
    v_dot2_f32_bf16 v238, v236, v236, 0
    v_dot2_f32_bf16 v238, v237, v237, v238
    v_or_b32 v236, 0x3f80, v236
    v_perm_b32 v231, v237, v236, v235
    v_and_b32 v239, 0x74, v230
    v_cvt_pk_bf16_f32 v238, 0, v238
    v_lshl_or_b32 v238, v239, 1, v238
    v_perm_b32 v230, v237, v236, v143
    s_mov_b64 exec, s[82:83]
    ds_write_b128 v179, v[228:231] offset:2816
    ds_write_b32 v183, v238 offset:2816
    s_mov_b64 exec, -1
    v_add_u32 v2, s64, v6
    v_add_u32 v3, s64, v7
    v_add_u32 v5, s64, v9
    v_add_u32 v232, s64, v8
    s_waitcnt vmcnt(63) lgkmcnt(0)
    s_barrier
    ds_read_b32 v10, v2
    ds_read_b128 v[228:231], v3
    ds_read_b64 v[218:219], v232
    buffer_load_dword v160, v160, s[4:7], 0 offen
    buffer_load_dword v161, v161, s[4:7], 0 offen
    buffer_load_dword v162, v162, s[4:7], 0 offen
    buffer_load_dword v163, v163, s[4:7], 0 offen
    buffer_load_dword v164, v164, s[4:7], 0 offen
    buffer_load_dword v165, v165, s[4:7], 0 offen
    buffer_load_dword v166, v166, s[4:7], 0 offen
    buffer_load_dword v167, v167, s[4:7], 0 offen
    s_waitcnt lgkmcnt(2)
    v_xor_b32_sdwa v2, v10, v18 dst_sel:DWORD dst_unused:UNUSED_PAD src0_sel:WORD_0 src1_sel:WORD_0
    ds_read_b64 v[216:217], v2
    buffer_load_dword v168, v168, s[4:7], 0 offen
    buffer_load_dword v169, v169, s[4:7], 0 offen
    buffer_load_dword v170, v170, s[4:7], 0 offen
    buffer_load_dword v171, v171, s[4:7], 0 offen
    buffer_load_dword v172, v172, s[4:7], 0 offen
    buffer_load_dword v173, v173, s[4:7], 0 offen
    buffer_load_dword v174, v174, s[4:7], 0 offen
    buffer_load_dword v175, v175, s[4:7], 0 offen
    s_waitcnt lgkmcnt(0)
    v_perm_b32 v219, v10, v219, v12
    s_mov_b32 s73, 0x0
    s_cmp_gt_u32 s52, 3
    s_cselect_b32 s73, 0x110, s73
    s_bitcmp1_b32 s73, 0
    s_cselect_b64 vcc, -1, 0
    s_setprio 2
    s_branch M_SEL
M_FULL0:
    v_readlane_b32 s63, v13, s61
    v_lshl_add_u32 v228, v228, 16, v5
    v_lshl_add_u32 v229, v229, 16, v5
    v_lshl_add_u32 v230, v230, 16, v5
    v_lshl_add_u32 v231, v231, 16, v5
    s_waitcnt vmcnt(16)
    v_mfma_f32_32x32x16_bf16 v[192:207], v[216:219], v[124:127], v[144:159]
    ds_read_b64_tr_b16 v[220:221], v228 offset:8
    ds_read_b64_tr_b16 v[222:223], v229 offset:40
    ds_read_b64_tr_b16 v[224:225], v230 offset:264
    ds_read_b64_tr_b16 v[226:227], v231 offset:296
    v_lshlrev_b64 v[176:177], 16, v[144:145]
    v_lshlrev_b64 v[178:179], 16, v[146:147]
    v_lshlrev_b64 v[180:181], 16, v[148:149]
    v_lshlrev_b64 v[182:183], 16, v[150:151]
    v_lshlrev_b64 v[184:185], 16, v[152:153]
    v_lshlrev_b64 v[186:187], 16, v[154:155]
    v_lshlrev_b64 v[188:189], 16, v[156:157]
    v_lshlrev_b64 v[190:191], 16, v[158:159]
    s_lshr_b32 s75, s63, 16
    v_add_u32 v4, s75, v11
    v_mfma_f32_32x32x16_bf16 v[176:191], v[216:219], v[120:123], v[176:191]
    ds_read_b128 v[144:147], v4 offset:0
    ds_read_b128 v[148:151], v4 offset:32
    ds_read_b128 v[152:155], v4 offset:64
    ds_read_b128 v[156:159], v4 offset:96
    s_and_b32 s74, s63, 0xff00
    s_and_b32 s75, s63, 0xff00
    v_lshl_add_u64 v[2:3], v[6:7], 0, s[74:75]
    v_lshl_add_u64 v[4:5], v[8:9], 0, s[74:75]
    s_add_u32 s61, s61, 1
    ds_read_b32 v10, v2
    ds_read_b128 v[228:231], v3
    ds_read_b64 v[218:219], v4
    v_lshlrev_b32_sdwa v176, 1, v176 dst_sel:DWORD dst_unused:UNUSED_PAD src0_sel:DWORD src1_sel:WORD_1
    v_lshlrev_b32_sdwa v177, 1, v177 dst_sel:DWORD dst_unused:UNUSED_PAD src0_sel:DWORD src1_sel:WORD_1
    v_lshlrev_b32_sdwa v178, 1, v178 dst_sel:DWORD dst_unused:UNUSED_PAD src0_sel:DWORD src1_sel:WORD_1
    v_lshlrev_b32_sdwa v179, 1, v179 dst_sel:DWORD dst_unused:UNUSED_PAD src0_sel:DWORD src1_sel:WORD_1
    v_lshlrev_b32_sdwa v180, 1, v180 dst_sel:DWORD dst_unused:UNUSED_PAD src0_sel:DWORD src1_sel:WORD_1
    v_lshlrev_b32_sdwa v181, 1, v181 dst_sel:DWORD dst_unused:UNUSED_PAD src0_sel:DWORD src1_sel:WORD_1
    v_lshlrev_b32_sdwa v182, 1, v182 dst_sel:DWORD dst_unused:UNUSED_PAD src0_sel:DWORD src1_sel:WORD_1
    v_lshlrev_b32_sdwa v183, 1, v183 dst_sel:DWORD dst_unused:UNUSED_PAD src0_sel:DWORD src1_sel:WORD_1
    s_waitcnt lgkmcnt(3)
    ds_read_u16 v176, v176 offset:64256
    ds_read_u16 v177, v177 offset:64256
    ds_read_u16 v178, v178 offset:64256
    ds_read_u16 v179, v179 offset:64256
    buffer_load_dword v144, v144, s[4:7], 0 offen
    buffer_load_dword v145, v145, s[4:7], 0 offen
    buffer_load_dword v146, v146, s[4:7], 0 offen
    buffer_load_dword v147, v147, s[4:7], 0 offen
    ds_read_u16_d16_hi v180, v180 offset:64256
    ds_read_u16_d16_hi v181, v181 offset:64256
    ds_read_u16_d16_hi v182, v182 offset:64256
    ds_read_u16_d16_hi v183, v183 offset:64256
    buffer_load_dword v148, v148, s[4:7], 0 offen
    buffer_load_dword v149, v149, s[4:7], 0 offen
    buffer_load_dword v150, v150, s[4:7], 0 offen
    buffer_load_dword v151, v151, s[4:7], 0 offen
    s_waitcnt lgkmcnt(8)
    v_lshlrev_b32_sdwa v184, 1, v184 dst_sel:DWORD dst_unused:UNUSED_PAD src0_sel:DWORD src1_sel:WORD_1
    v_lshlrev_b32_sdwa v185, 1, v185 dst_sel:DWORD dst_unused:UNUSED_PAD src0_sel:DWORD src1_sel:WORD_1
    v_lshlrev_b32_sdwa v186, 1, v186 dst_sel:DWORD dst_unused:UNUSED_PAD src0_sel:DWORD src1_sel:WORD_1
    v_lshlrev_b32_sdwa v187, 1, v187 dst_sel:DWORD dst_unused:UNUSED_PAD src0_sel:DWORD src1_sel:WORD_1
    v_lshlrev_b32_sdwa v188, 1, v188 dst_sel:DWORD dst_unused:UNUSED_PAD src0_sel:DWORD src1_sel:WORD_1
    v_lshlrev_b32_sdwa v189, 1, v189 dst_sel:DWORD dst_unused:UNUSED_PAD src0_sel:DWORD src1_sel:WORD_1
    v_lshlrev_b32_sdwa v190, 1, v190 dst_sel:DWORD dst_unused:UNUSED_PAD src0_sel:DWORD src1_sel:WORD_1
    v_lshlrev_b32_sdwa v191, 1, v191 dst_sel:DWORD dst_unused:UNUSED_PAD src0_sel:DWORD src1_sel:WORD_1
    v_xor_b32_sdwa v2, v10, v18 dst_sel:DWORD dst_unused:UNUSED_PAD src0_sel:WORD_0 src1_sel:WORD_0
    v_perm_b32 v219, v10, v219, v12
    s_nop 0
    buffer_load_dword v152, v152, s[4:7], 0 offen
    buffer_load_dword v153, v153, s[4:7], 0 offen
    buffer_load_dword v154, v154, s[4:7], 0 offen
    buffer_load_dword v155, v155, s[4:7], 0 offen
    ds_read_u16 v184, v184 offset:64256
    ds_read_u16 v185, v185 offset:64256
    ds_read_u16 v186, v186 offset:64256
    ds_read_u16 v187, v187 offset:64256
    buffer_load_dword v156, v156, s[4:7], 0 offen
    buffer_load_dword v157, v157, s[4:7], 0 offen
    buffer_load_dword v158, v158, s[4:7], 0 offen
    buffer_load_dword v159, v159, s[4:7], 0 offen
    s_waitcnt lgkmcnt(8)
    ds_read_u16_d16_hi v188, v188 offset:64256
    ds_read_u16_d16_hi v189, v189 offset:64256
    ds_read_u16_d16_hi v190, v190 offset:64256
    ds_read_u16_d16_hi v191, v191 offset:64256
    ds_read_b64 v[216:217], v2
    s_setprio 0
    s_cbranch_vccz M_PR1
    s_setprio 1
M_PR1:
    v_exp_f32 v232, -v192
    v_exp_f32 v233, -v193
    v_exp_f32 v234, -v194
    v_exp_f32 v235, -v195
    v_exp_f32 v236, -v196
    v_exp_f32 v237, -v197
    v_exp_f32 v238, -v198
    v_exp_f32 v239, -v199
    v_exp_f32 v240, -v200
    v_exp_f32 v241, -v201
    v_exp_f32 v242, -v202
    v_exp_f32 v243, -v203
    v_exp_f32 v244, -v204
    v_exp_f32 v245, -v205
    v_exp_f32 v246, -v206
    v_exp_f32 v247, -v207
    v_pk_add_f32 v[232:233], v[232:233], 1.0 op_sel_hi:[1,0]
    v_pk_add_f32 v[234:235], v[234:235], 1.0 op_sel_hi:[1,0]
    v_pk_add_f32 v[236:237], v[236:237], 1.0 op_sel_hi:[1,0]
    v_pk_add_f32 v[238:239], v[238:239], 1.0 op_sel_hi:[1,0]
    v_pk_add_f32 v[240:241], v[240:241], 1.0 op_sel_hi:[1,0]
    v_pk_add_f32 v[242:243], v[242:243], 1.0 op_sel_hi:[1,0]
    v_pk_add_f32 v[244:245], v[244:245], 1.0 op_sel_hi:[1,0]
    v_pk_add_f32 v[246:247], v[246:247], 1.0 op_sel_hi:[1,0]
    v_rcp_f32 v232, v232
    v_rcp_f32 v233, v233
    v_rcp_f32 v234, v234
    v_rcp_f32 v235, v235
    v_rcp_f32 v236, v236
    v_rcp_f32 v237, v237
    v_rcp_f32 v238, v238
    v_rcp_f32 v239, v239
    v_rcp_f32 v240, v240
    v_rcp_f32 v241, v241
    v_rcp_f32 v242, v242
    v_rcp_f32 v243, v243
    v_rcp_f32 v244, v244
    v_rcp_f32 v245, v245
    v_rcp_f32 v246, v246
    v_rcp_f32 v247, v247
    v_pk_mul_f32 v[192:193], v[192:193], v[232:233]
    v_pk_mul_f32 v[194:195], v[194:195], v[234:235]
    v_pk_mul_f32 v[196:197], v[196:197], v[236:237]
    v_pk_mul_f32 v[198:199], v[198:199], v[238:239]
    v_pk_mul_f32 v[200:201], v[200:201], v[240:241]
    v_pk_mul_f32 v[202:203], v[202:203], v[242:243]
    v_pk_mul_f32 v[204:205], v[204:205], v[244:245]
    v_pk_mul_f32 v[206:207], v[206:207], v[246:247]
    s_waitcnt lgkmcnt(9)
    v_or_b32 v176, v176, v180
    v_or_b32 v177, v177, v181
    v_or_b32 v178, v178, v182
    v_or_b32 v179, v179, v183
    s_setprio 2
    v_cvt_pk_bf16_f32 v208, v192, v196
    v_cvt_pk_bf16_f32 v209, v193, v197
    v_cvt_pk_bf16_f32 v210, v194, v198
    v_cvt_pk_bf16_f32 v211, v195, v199
    v_mfma_f32_32x32x16_bf16 v[40:55], v[176:179], v[220:223], v[40:55]
    s_waitcnt lgkmcnt(1)
    v_or_b32 v184, v184, v188
    v_or_b32 v185, v185, v189
    v_or_b32 v186, v186, v190
    v_or_b32 v187, v187, v191
    v_cvt_pk_bf16_f32 v212, v200, v204
    v_cvt_pk_bf16_f32 v213, v201, v205
    v_cvt_pk_bf16_f32 v214, v202, v206
    v_cvt_pk_bf16_f32 v215, v203, v207
    v_mfma_f32_32x32x16_bf16 v[40:55], v[184:187], v[224:227], v[40:55]
    s_waitcnt lgkmcnt(0)
    v_mfma_f32_32x32x16_bf16 v[56:71], v[208:211], v[220:223], v[56:71]
    v_mfma_f32_32x32x16_bf16 v[56:71], v[212:215], v[224:227], v[56:71]
    s_bitcmp1_b32 s63, 4
    s_cbranch_scc0 M_OTH1
M_FULL1:
    v_readlane_b32 s63, v13, s61
    v_lshl_add_u32 v228, v228, 16, v5
    v_lshl_add_u32 v229, v229, 16, v5
    v_lshl_add_u32 v230, v230, 16, v5
    v_lshl_add_u32 v231, v231, 16, v5
    s_waitcnt vmcnt(16)
    v_mfma_f32_32x32x16_bf16 v[192:207], v[216:219], v[124:127], v[160:175]
    ds_read_b64_tr_b16 v[220:221], v228 offset:8
    ds_read_b64_tr_b16 v[222:223], v229 offset:40
    ds_read_b64_tr_b16 v[224:225], v230 offset:264
    ds_read_b64_tr_b16 v[226:227], v231 offset:296
    v_lshlrev_b64 v[176:177], 16, v[160:161]
    v_lshlrev_b64 v[178:179], 16, v[162:163]
    v_lshlrev_b64 v[180:181], 16, v[164:165]
    v_lshlrev_b64 v[182:183], 16, v[166:167]
    v_lshlrev_b64 v[184:185], 16, v[168:169]
    v_lshlrev_b64 v[186:187], 16, v[170:171]
    v_lshlrev_b64 v[188:189], 16, v[172:173]
    v_lshlrev_b64 v[190:191], 16, v[174:175]
    s_lshr_b32 s75, s63, 16
    v_add_u32 v4, s75, v11
    v_mfma_f32_32x32x16_bf16 v[176:191], v[216:219], v[120:123], v[176:191]
    ds_read_b128 v[160:163], v4 offset:0
    ds_read_b128 v[164:167], v4 offset:32
    ds_read_b128 v[168:171], v4 offset:64
    ds_read_b128 v[172:175], v4 offset:96
    s_and_b32 s74, s63, 0xff00
    s_and_b32 s75, s63, 0xff00
    v_lshl_add_u64 v[2:3], v[6:7], 0, s[74:75]
    v_lshl_add_u64 v[4:5], v[8:9], 0, s[74:75]
    s_add_u32 s61, s61, 1
    ds_read_b32 v10, v2
    ds_read_b128 v[228:231], v3
    ds_read_b64 v[218:219], v4
    v_lshlrev_b32_sdwa v176, 1, v176 dst_sel:DWORD dst_unused:UNUSED_PAD src0_sel:DWORD src1_sel:WORD_1
    v_lshlrev_b32_sdwa v177, 1, v177 dst_sel:DWORD dst_unused:UNUSED_PAD src0_sel:DWORD src1_sel:WORD_1
    v_lshlrev_b32_sdwa v178, 1, v178 dst_sel:DWORD dst_unused:UNUSED_PAD src0_sel:DWORD src1_sel:WORD_1
    v_lshlrev_b32_sdwa v179, 1, v179 dst_sel:DWORD dst_unused:UNUSED_PAD src0_sel:DWORD src1_sel:WORD_1
    v_lshlrev_b32_sdwa v180, 1, v180 dst_sel:DWORD dst_unused:UNUSED_PAD src0_sel:DWORD src1_sel:WORD_1
    v_lshlrev_b32_sdwa v181, 1, v181 dst_sel:DWORD dst_unused:UNUSED_PAD src0_sel:DWORD src1_sel:WORD_1
    v_lshlrev_b32_sdwa v182, 1, v182 dst_sel:DWORD dst_unused:UNUSED_PAD src0_sel:DWORD src1_sel:WORD_1
    v_lshlrev_b32_sdwa v183, 1, v183 dst_sel:DWORD dst_unused:UNUSED_PAD src0_sel:DWORD src1_sel:WORD_1
    s_waitcnt lgkmcnt(3)
    ds_read_u16 v176, v176 offset:64256
    ds_read_u16 v177, v177 offset:64256
    ds_read_u16 v178, v178 offset:64256
    ds_read_u16 v179, v179 offset:64256
    buffer_load_dword v160, v160, s[4:7], 0 offen
    buffer_load_dword v161, v161, s[4:7], 0 offen
    buffer_load_dword v162, v162, s[4:7], 0 offen
    buffer_load_dword v163, v163, s[4:7], 0 offen
    ds_read_u16_d16_hi v180, v180 offset:64256
    ds_read_u16_d16_hi v181, v181 offset:64256
    ds_read_u16_d16_hi v182, v182 offset:64256
    ds_read_u16_d16_hi v183, v183 offset:64256
    buffer_load_dword v164, v164, s[4:7], 0 offen
    buffer_load_dword v165, v165, s[4:7], 0 offen
    buffer_load_dword v166, v166, s[4:7], 0 offen
    buffer_load_dword v167, v167, s[4:7], 0 offen
    s_waitcnt lgkmcnt(8)
    v_lshlrev_b32_sdwa v184, 1, v184 dst_sel:DWORD dst_unused:UNUSED_PAD src0_sel:DWORD src1_sel:WORD_1
    v_lshlrev_b32_sdwa v185, 1, v185 dst_sel:DWORD dst_unused:UNUSED_PAD src0_sel:DWORD src1_sel:WORD_1
    v_lshlrev_b32_sdwa v186, 1, v186 dst_sel:DWORD dst_unused:UNUSED_PAD src0_sel:DWORD src1_sel:WORD_1
    v_lshlrev_b32_sdwa v187, 1, v187 dst_sel:DWORD dst_unused:UNUSED_PAD src0_sel:DWORD src1_sel:WORD_1
    v_lshlrev_b32_sdwa v188, 1, v188 dst_sel:DWORD dst_unused:UNUSED_PAD src0_sel:DWORD src1_sel:WORD_1
    v_lshlrev_b32_sdwa v189, 1, v189 dst_sel:DWORD dst_unused:UNUSED_PAD src0_sel:DWORD src1_sel:WORD_1
    v_lshlrev_b32_sdwa v190, 1, v190 dst_sel:DWORD dst_unused:UNUSED_PAD src0_sel:DWORD src1_sel:WORD_1
    v_lshlrev_b32_sdwa v191, 1, v191 dst_sel:DWORD dst_unused:UNUSED_PAD src0_sel:DWORD src1_sel:WORD_1
    v_xor_b32_sdwa v2, v10, v18 dst_sel:DWORD dst_unused:UNUSED_PAD src0_sel:WORD_0 src1_sel:WORD_0
    v_perm_b32 v219, v10, v219, v12
    s_nop 0
    buffer_load_dword v168, v168, s[4:7], 0 offen
    buffer_load_dword v169, v169, s[4:7], 0 offen
    buffer_load_dword v170, v170, s[4:7], 0 offen
    buffer_load_dword v171, v171, s[4:7], 0 offen
    ds_read_u16 v184, v184 offset:64256
    ds_read_u16 v185, v185 offset:64256
    ds_read_u16 v186, v186 offset:64256
    ds_read_u16 v187, v187 offset:64256
    buffer_load_dword v172, v172, s[4:7], 0 offen
    buffer_load_dword v173, v173, s[4:7], 0 offen
    buffer_load_dword v174, v174, s[4:7], 0 offen
    buffer_load_dword v175, v175, s[4:7], 0 offen
    s_waitcnt lgkmcnt(8)
    ds_read_u16_d16_hi v188, v188 offset:64256
    ds_read_u16_d16_hi v189, v189 offset:64256
    ds_read_u16_d16_hi v190, v190 offset:64256
    ds_read_u16_d16_hi v191, v191 offset:64256
    ds_read_b64 v[216:217], v2
    s_setprio 0
    s_cbranch_vccz M_PR2
    s_setprio 1
M_PR2:
    v_exp_f32 v232, -v192
    v_exp_f32 v233, -v193
    v_exp_f32 v234, -v194
    v_exp_f32 v235, -v195
    v_exp_f32 v236, -v196
    v_exp_f32 v237, -v197
    v_exp_f32 v238, -v198
    v_exp_f32 v239, -v199
    v_exp_f32 v240, -v200
    v_exp_f32 v241, -v201
    v_exp_f32 v242, -v202
    v_exp_f32 v243, -v203
    v_exp_f32 v244, -v204
    v_exp_f32 v245, -v205
    v_exp_f32 v246, -v206
    v_exp_f32 v247, -v207
    v_pk_add_f32 v[232:233], v[232:233], 1.0 op_sel_hi:[1,0]
    v_pk_add_f32 v[234:235], v[234:235], 1.0 op_sel_hi:[1,0]
    v_pk_add_f32 v[236:237], v[236:237], 1.0 op_sel_hi:[1,0]
    v_pk_add_f32 v[238:239], v[238:239], 1.0 op_sel_hi:[1,0]
    v_pk_add_f32 v[240:241], v[240:241], 1.0 op_sel_hi:[1,0]
    v_pk_add_f32 v[242:243], v[242:243], 1.0 op_sel_hi:[1,0]
    v_pk_add_f32 v[244:245], v[244:245], 1.0 op_sel_hi:[1,0]
    v_pk_add_f32 v[246:247], v[246:247], 1.0 op_sel_hi:[1,0]
    v_rcp_f32 v232, v232
    v_rcp_f32 v233, v233
    v_rcp_f32 v234, v234
    v_rcp_f32 v235, v235
    v_rcp_f32 v236, v236
    v_rcp_f32 v237, v237
    v_rcp_f32 v238, v238
    v_rcp_f32 v239, v239
    v_rcp_f32 v240, v240
    v_rcp_f32 v241, v241
    v_rcp_f32 v242, v242
    v_rcp_f32 v243, v243
    v_rcp_f32 v244, v244
    v_rcp_f32 v245, v245
    v_rcp_f32 v246, v246
    v_rcp_f32 v247, v247
    v_pk_mul_f32 v[192:193], v[192:193], v[232:233]
    v_pk_mul_f32 v[194:195], v[194:195], v[234:235]
    v_pk_mul_f32 v[196:197], v[196:197], v[236:237]
    v_pk_mul_f32 v[198:199], v[198:199], v[238:239]
    v_pk_mul_f32 v[200:201], v[200:201], v[240:241]
    v_pk_mul_f32 v[202:203], v[202:203], v[242:243]
    v_pk_mul_f32 v[204:205], v[204:205], v[244:245]
    v_pk_mul_f32 v[206:207], v[206:207], v[246:247]
    s_waitcnt lgkmcnt(9)
    v_or_b32 v176, v176, v180
    v_or_b32 v177, v177, v181
    v_or_b32 v178, v178, v182
    v_or_b32 v179, v179, v183
    s_setprio 2
    v_cvt_pk_bf16_f32 v208, v192, v196
    v_cvt_pk_bf16_f32 v209, v193, v197
    v_cvt_pk_bf16_f32 v210, v194, v198
    v_cvt_pk_bf16_f32 v211, v195, v199
    v_mfma_f32_32x32x16_bf16 v[40:55], v[176:179], v[220:223], v[40:55]
    s_waitcnt lgkmcnt(1)
    v_or_b32 v184, v184, v188
    v_or_b32 v185, v185, v189
    v_or_b32 v186, v186, v190
    v_or_b32 v187, v187, v191
    v_cvt_pk_bf16_f32 v212, v200, v204
    v_cvt_pk_bf16_f32 v213, v201, v205
    v_cvt_pk_bf16_f32 v214, v202, v206
    v_cvt_pk_bf16_f32 v215, v203, v207
    v_mfma_f32_32x32x16_bf16 v[40:55], v[184:187], v[224:227], v[40:55]
    s_waitcnt lgkmcnt(0)
    v_mfma_f32_32x32x16_bf16 v[56:71], v[208:211], v[220:223], v[56:71]
    v_mfma_f32_32x32x16_bf16 v[56:71], v[212:215], v[224:227], v[56:71]
    s_bitcmp1_b32 s63, 4
    s_cbranch_scc1 M_FULL0
M_OTH0:
    s_bitcmp0_b32 s63, 3
    s_cbranch_scc1 M_LAST0
    v_readlane_b32 s63, v13, s61
    v_xor_b32 v18, 8, v18
    v_add_u32 v9, s10, v9
    v_xor_b32_sdwa v2, v10, v18 dst_sel:DWORD dst_unused:UNUSED_PAD src0_sel:WORD_0 src1_sel:WORD_0
    v_lshl_add_u32 v228, v228, 16, v5
    v_lshl_add_u32 v229, v229, 16, v5
    v_lshl_add_u32 v230, v230, 16, v5
    v_lshl_add_u32 v231, v231, 16, v5
    s_waitcnt vmcnt(16)
    v_mfma_f32_32x32x16_bf16 v[192:207], v[216:219], v[124:127], v[144:159]
    ds_read_b64 v[232:233], v2
    ds_read_b64_tr_b16 v[220:221], v228 offset:8
    ds_read_b64_tr_b16 v[222:223], v229 offset:40
    ds_read_b64_tr_b16 v[224:225], v230 offset:264
    ds_read_b64_tr_b16 v[226:227], v231 offset:296
    v_lshlrev_b64 v[176:177], 16, v[144:145]
    v_lshlrev_b64 v[178:179], 16, v[146:147]
    v_lshlrev_b64 v[180:181], 16, v[148:149]
    v_lshlrev_b64 v[182:183], 16, v[150:151]
    v_lshlrev_b64 v[184:185], 16, v[152:153]
    v_lshlrev_b64 v[186:187], 16, v[154:155]
    v_lshlrev_b64 v[188:189], 16, v[156:157]
    v_lshlrev_b64 v[190:191], 16, v[158:159]
    s_lshr_b32 s75, s63, 16
    v_add_u32 v4, s75, v11
    v_mfma_f32_32x32x16_bf16 v[176:191], v[216:219], v[120:123], v[176:191]
    ds_read_b128 v[144:147], v4 offset:0
    ds_read_b128 v[148:151], v4 offset:32
    ds_read_b128 v[152:155], v4 offset:64
    ds_read_b128 v[156:159], v4 offset:96
    v_mov_b64 v[234:235], 0
    s_add_u32 s55, s62, 4
    s_and_b32 s55, s55, 12
    s_set_gpr_idx_on s55, gpr_idx(SRC0)
    v_mov_b32 v120, v104
    v_mov_b32 v121, v105
    v_mov_b32 v124, v106
    v_mov_b32 v125, v107
    s_set_gpr_idx_off
    s_waitcnt lgkmcnt(8)
    v_mfma_f32_32x32x16_bf16 v[176:191], v[232:235], v[120:123], v[176:191]
    s_and_b32 s74, s63, 0xff00
    s_and_b32 s75, s63, 0xff00
    v_lshl_add_u64 v[2:3], v[6:7], 0, s[74:75]
    v_lshl_add_u64 v[4:5], v[8:9], 0, s[74:75]
    v_add_u32 v228, s10, v228
    v_add_u32 v229, s10, v229
    v_add_u32 v230, s10, v230
    v_add_u32 v231, s10, v231
    v_mfma_f32_32x32x16_bf16 v[192:207], v[232:235], v[124:127], v[192:207]
    s_add_u32 s61, s61, 1
    ds_read_b32 v10, v2
    ds_read_b64 v[218:219], v4
    v_lshlrev_b32_sdwa v176, 1, v176 dst_sel:DWORD dst_unused:UNUSED_PAD src0_sel:DWORD src1_sel:WORD_1
    v_lshlrev_b32_sdwa v177, 1, v177 dst_sel:DWORD dst_unused:UNUSED_PAD src0_sel:DWORD src1_sel:WORD_1
    v_lshlrev_b32_sdwa v178, 1, v178 dst_sel:DWORD dst_unused:UNUSED_PAD src0_sel:DWORD src1_sel:WORD_1
    v_lshlrev_b32_sdwa v179, 1, v179 dst_sel:DWORD dst_unused:UNUSED_PAD src0_sel:DWORD src1_sel:WORD_1
    v_lshlrev_b32_sdwa v180, 1, v180 dst_sel:DWORD dst_unused:UNUSED_PAD src0_sel:DWORD src1_sel:WORD_1
    v_lshlrev_b32_sdwa v181, 1, v181 dst_sel:DWORD dst_unused:UNUSED_PAD src0_sel:DWORD src1_sel:WORD_1
    v_lshlrev_b32_sdwa v182, 1, v182 dst_sel:DWORD dst_unused:UNUSED_PAD src0_sel:DWORD src1_sel:WORD_1
    v_lshlrev_b32_sdwa v183, 1, v183 dst_sel:DWORD dst_unused:UNUSED_PAD src0_sel:DWORD src1_sel:WORD_1
    s_waitcnt lgkmcnt(2)
    ds_read_u16 v176, v176 offset:64256
    ds_read_u16 v177, v177 offset:64256
    ds_read_u16 v178, v178 offset:64256
    ds_read_u16 v179, v179 offset:64256
    buffer_load_dword v144, v144, s[4:7], 0 offen
    buffer_load_dword v145, v145, s[4:7], 0 offen
    buffer_load_dword v146, v146, s[4:7], 0 offen
    buffer_load_dword v147, v147, s[4:7], 0 offen
    ds_read_u16_d16_hi v180, v180 offset:64256
    ds_read_u16_d16_hi v181, v181 offset:64256
    ds_read_u16_d16_hi v182, v182 offset:64256
    ds_read_u16_d16_hi v183, v183 offset:64256
    buffer_load_dword v148, v148, s[4:7], 0 offen
    buffer_load_dword v149, v149, s[4:7], 0 offen
    buffer_load_dword v150, v150, s[4:7], 0 offen
    buffer_load_dword v151, v151, s[4:7], 0 offen
    s_waitcnt lgkmcnt(8)
    v_lshlrev_b32_sdwa v184, 1, v184 dst_sel:DWORD dst_unused:UNUSED_PAD src0_sel:DWORD src1_sel:WORD_1
    v_lshlrev_b32_sdwa v185, 1, v185 dst_sel:DWORD dst_unused:UNUSED_PAD src0_sel:DWORD src1_sel:WORD_1
    v_lshlrev_b32_sdwa v186, 1, v186 dst_sel:DWORD dst_unused:UNUSED_PAD src0_sel:DWORD src1_sel:WORD_1
    v_lshlrev_b32_sdwa v187, 1, v187 dst_sel:DWORD dst_unused:UNUSED_PAD src0_sel:DWORD src1_sel:WORD_1
    v_lshlrev_b32_sdwa v188, 1, v188 dst_sel:DWORD dst_unused:UNUSED_PAD src0_sel:DWORD src1_sel:WORD_1
    v_lshlrev_b32_sdwa v189, 1, v189 dst_sel:DWORD dst_unused:UNUSED_PAD src0_sel:DWORD src1_sel:WORD_1
    v_lshlrev_b32_sdwa v190, 1, v190 dst_sel:DWORD dst_unused:UNUSED_PAD src0_sel:DWORD src1_sel:WORD_1
    v_lshlrev_b32_sdwa v191, 1, v191 dst_sel:DWORD dst_unused:UNUSED_PAD src0_sel:DWORD src1_sel:WORD_1
    v_xor_b32_sdwa v2, v10, v18 dst_sel:DWORD dst_unused:UNUSED_PAD src0_sel:WORD_0 src1_sel:WORD_0
    v_perm_b32 v219, v10, v219, v12
    s_nop 0
    buffer_load_dword v152, v152, s[4:7], 0 offen
    buffer_load_dword v153, v153, s[4:7], 0 offen
    buffer_load_dword v154, v154, s[4:7], 0 offen
    buffer_load_dword v155, v155, s[4:7], 0 offen
    ds_read_u16 v184, v184 offset:64256
    ds_read_u16 v185, v185 offset:64256
    ds_read_u16 v186, v186 offset:64256
    ds_read_u16 v187, v187 offset:64256
    buffer_load_dword v156, v156, s[4:7], 0 offen
    buffer_load_dword v157, v157, s[4:7], 0 offen
    buffer_load_dword v158, v158, s[4:7], 0 offen
    buffer_load_dword v159, v159, s[4:7], 0 offen
    s_waitcnt lgkmcnt(8)
    ds_read_u16_d16_hi v188, v188 offset:64256
    ds_read_u16_d16_hi v189, v189 offset:64256
    ds_read_u16_d16_hi v190, v190 offset:64256
    ds_read_u16_d16_hi v191, v191 offset:64256
    ds_read_b64 v[216:217], v2
    s_setprio 0
    s_cbranch_vccz M_PR3
    s_setprio 1
M_PR3:
    v_exp_f32 v232, -v192
    v_exp_f32 v233, -v193
    v_exp_f32 v234, -v194
    v_exp_f32 v235, -v195
    v_exp_f32 v236, -v196
    v_exp_f32 v237, -v197
    v_exp_f32 v238, -v198
    v_exp_f32 v239, -v199
    v_exp_f32 v240, -v200
    v_exp_f32 v241, -v201
    v_exp_f32 v242, -v202
    v_exp_f32 v243, -v203
    v_exp_f32 v244, -v204
    v_exp_f32 v245, -v205
    v_exp_f32 v246, -v206
    v_exp_f32 v247, -v207
    v_pk_add_f32 v[232:233], v[232:233], 1.0 op_sel_hi:[1,0]
    v_pk_add_f32 v[234:235], v[234:235], 1.0 op_sel_hi:[1,0]
    v_pk_add_f32 v[236:237], v[236:237], 1.0 op_sel_hi:[1,0]
    v_pk_add_f32 v[238:239], v[238:239], 1.0 op_sel_hi:[1,0]
    v_pk_add_f32 v[240:241], v[240:241], 1.0 op_sel_hi:[1,0]
    v_pk_add_f32 v[242:243], v[242:243], 1.0 op_sel_hi:[1,0]
    v_pk_add_f32 v[244:245], v[244:245], 1.0 op_sel_hi:[1,0]
    v_pk_add_f32 v[246:247], v[246:247], 1.0 op_sel_hi:[1,0]
    v_rcp_f32 v232, v232
    v_rcp_f32 v233, v233
    v_rcp_f32 v234, v234
    v_rcp_f32 v235, v235
    v_rcp_f32 v236, v236
    v_rcp_f32 v237, v237
    v_rcp_f32 v238, v238
    v_rcp_f32 v239, v239
    v_rcp_f32 v240, v240
    v_rcp_f32 v241, v241
    v_rcp_f32 v242, v242
    v_rcp_f32 v243, v243
    v_rcp_f32 v244, v244
    v_rcp_f32 v245, v245
    v_rcp_f32 v246, v246
    v_rcp_f32 v247, v247
    v_pk_mul_f32 v[192:193], v[192:193], v[232:233]
    v_pk_mul_f32 v[194:195], v[194:195], v[234:235]
    v_pk_mul_f32 v[196:197], v[196:197], v[236:237]
    v_pk_mul_f32 v[198:199], v[198:199], v[238:239]
    v_pk_mul_f32 v[200:201], v[200:201], v[240:241]
    v_pk_mul_f32 v[202:203], v[202:203], v[242:243]
    v_pk_mul_f32 v[204:205], v[204:205], v[244:245]
    v_pk_mul_f32 v[206:207], v[206:207], v[246:247]
    s_waitcnt lgkmcnt(9)
    v_or_b32 v176, v176, v180
    v_or_b32 v177, v177, v181
    v_or_b32 v178, v178, v182
    v_or_b32 v179, v179, v183
    s_setprio 2
    v_cvt_pk_bf16_f32 v208, v192, v196
    v_cvt_pk_bf16_f32 v209, v193, v197
    v_cvt_pk_bf16_f32 v210, v194, v198
    v_cvt_pk_bf16_f32 v211, v195, v199
    v_mfma_f32_32x32x16_bf16 v[40:55], v[176:179], v[220:223], v[40:55]
    s_waitcnt lgkmcnt(1)
    v_or_b32 v184, v184, v188
    v_or_b32 v185, v185, v189
    v_or_b32 v186, v186, v190
    v_or_b32 v187, v187, v191
    v_cvt_pk_bf16_f32 v212, v200, v204
    v_cvt_pk_bf16_f32 v213, v201, v205
    v_cvt_pk_bf16_f32 v214, v202, v206
    v_cvt_pk_bf16_f32 v215, v203, v207
    v_mfma_f32_32x32x16_bf16 v[40:55], v[184:187], v[224:227], v[40:55]
    s_waitcnt lgkmcnt(0)
    ds_read_b128 v[232:235], v15 offset:256
    ds_read_b128 v[236:239], v15 offset:288
    ds_read_b128 v[240:243], v15 offset:320
    ds_read_b128 v[244:247], v15 offset:352
    v_mfma_f32_32x32x16_bf16 v[56:71], v[208:211], v[220:223], v[56:71]
    ds_read_b128 v[192:195], v15 offset:384
    ds_read_b128 v[196:199], v15 offset:416
    ds_read_b128 v[200:203], v15 offset:448
    ds_read_b128 v[204:207], v15 offset:480
    v_mfma_f32_32x32x16_bf16 v[56:71], v[212:215], v[224:227], v[56:71]
    s_branch M_FLUSH2
M_OTH1:
    s_bitcmp0_b32 s63, 3
    s_cbranch_scc1 M_LAST1
    v_readlane_b32 s63, v13, s61
    v_xor_b32 v18, 8, v18
    v_add_u32 v9, s10, v9
    v_xor_b32_sdwa v2, v10, v18 dst_sel:DWORD dst_unused:UNUSED_PAD src0_sel:WORD_0 src1_sel:WORD_0
    v_lshl_add_u32 v228, v228, 16, v5
    v_lshl_add_u32 v229, v229, 16, v5
    v_lshl_add_u32 v230, v230, 16, v5
    v_lshl_add_u32 v231, v231, 16, v5
    s_waitcnt vmcnt(16)
    v_mfma_f32_32x32x16_bf16 v[192:207], v[216:219], v[124:127], v[160:175]
    ds_read_b64 v[232:233], v2
    ds_read_b64_tr_b16 v[220:221], v228 offset:8
    ds_read_b64_tr_b16 v[222:223], v229 offset:40
    ds_read_b64_tr_b16 v[224:225], v230 offset:264
    ds_read_b64_tr_b16 v[226:227], v231 offset:296
    v_lshlrev_b64 v[176:177], 16, v[160:161]
    v_lshlrev_b64 v[178:179], 16, v[162:163]
    v_lshlrev_b64 v[180:181], 16, v[164:165]
    v_lshlrev_b64 v[182:183], 16, v[166:167]
    v_lshlrev_b64 v[184:185], 16, v[168:169]
    v_lshlrev_b64 v[186:187], 16, v[170:171]
    v_lshlrev_b64 v[188:189], 16, v[172:173]
    v_lshlrev_b64 v[190:191], 16, v[174:175]
    s_lshr_b32 s75, s63, 16
    v_add_u32 v4, s75, v11
    v_mfma_f32_32x32x16_bf16 v[176:191], v[216:219], v[120:123], v[176:191]
    ds_read_b128 v[160:163], v4 offset:0
    ds_read_b128 v[164:167], v4 offset:32
    ds_read_b128 v[168:171], v4 offset:64
    ds_read_b128 v[172:175], v4 offset:96
    v_mov_b64 v[234:235], 0
    s_add_u32 s55, s62, 4
    s_and_b32 s55, s55, 12
    s_set_gpr_idx_on s55, gpr_idx(SRC0)
    v_mov_b32 v120, v104
    v_mov_b32 v121, v105
    v_mov_b32 v124, v106
    v_mov_b32 v125, v107
    s_set_gpr_idx_off
    s_waitcnt lgkmcnt(8)
    v_mfma_f32_32x32x16_bf16 v[176:191], v[232:235], v[120:123], v[176:191]
    s_and_b32 s74, s63, 0xff00
    s_and_b32 s75, s63, 0xff00
    v_lshl_add_u64 v[2:3], v[6:7], 0, s[74:75]
    v_lshl_add_u64 v[4:5], v[8:9], 0, s[74:75]
    v_add_u32 v228, s10, v228
    v_add_u32 v229, s10, v229
    v_add_u32 v230, s10, v230
    v_add_u32 v231, s10, v231
    v_mfma_f32_32x32x16_bf16 v[192:207], v[232:235], v[124:127], v[192:207]
    s_add_u32 s61, s61, 1
    ds_read_b32 v10, v2
    ds_read_b64 v[218:219], v4
    v_lshlrev_b32_sdwa v176, 1, v176 dst_sel:DWORD dst_unused:UNUSED_PAD src0_sel:DWORD src1_sel:WORD_1
    v_lshlrev_b32_sdwa v177, 1, v177 dst_sel:DWORD dst_unused:UNUSED_PAD src0_sel:DWORD src1_sel:WORD_1
    v_lshlrev_b32_sdwa v178, 1, v178 dst_sel:DWORD dst_unused:UNUSED_PAD src0_sel:DWORD src1_sel:WORD_1
    v_lshlrev_b32_sdwa v179, 1, v179 dst_sel:DWORD dst_unused:UNUSED_PAD src0_sel:DWORD src1_sel:WORD_1
    v_lshlrev_b32_sdwa v180, 1, v180 dst_sel:DWORD dst_unused:UNUSED_PAD src0_sel:DWORD src1_sel:WORD_1
    v_lshlrev_b32_sdwa v181, 1, v181 dst_sel:DWORD dst_unused:UNUSED_PAD src0_sel:DWORD src1_sel:WORD_1
    v_lshlrev_b32_sdwa v182, 1, v182 dst_sel:DWORD dst_unused:UNUSED_PAD src0_sel:DWORD src1_sel:WORD_1
    v_lshlrev_b32_sdwa v183, 1, v183 dst_sel:DWORD dst_unused:UNUSED_PAD src0_sel:DWORD src1_sel:WORD_1
    s_waitcnt lgkmcnt(2)
    ds_read_u16 v176, v176 offset:64256
    ds_read_u16 v177, v177 offset:64256
    ds_read_u16 v178, v178 offset:64256
    ds_read_u16 v179, v179 offset:64256
    buffer_load_dword v160, v160, s[4:7], 0 offen
    buffer_load_dword v161, v161, s[4:7], 0 offen
    buffer_load_dword v162, v162, s[4:7], 0 offen
    buffer_load_dword v163, v163, s[4:7], 0 offen
    ds_read_u16_d16_hi v180, v180 offset:64256
    ds_read_u16_d16_hi v181, v181 offset:64256
    ds_read_u16_d16_hi v182, v182 offset:64256
    ds_read_u16_d16_hi v183, v183 offset:64256
    buffer_load_dword v164, v164, s[4:7], 0 offen
    buffer_load_dword v165, v165, s[4:7], 0 offen
    buffer_load_dword v166, v166, s[4:7], 0 offen
    buffer_load_dword v167, v167, s[4:7], 0 offen
    s_waitcnt lgkmcnt(8)
    v_lshlrev_b32_sdwa v184, 1, v184 dst_sel:DWORD dst_unused:UNUSED_PAD src0_sel:DWORD src1_sel:WORD_1
    v_lshlrev_b32_sdwa v185, 1, v185 dst_sel:DWORD dst_unused:UNUSED_PAD src0_sel:DWORD src1_sel:WORD_1
    v_lshlrev_b32_sdwa v186, 1, v186 dst_sel:DWORD dst_unused:UNUSED_PAD src0_sel:DWORD src1_sel:WORD_1
    v_lshlrev_b32_sdwa v187, 1, v187 dst_sel:DWORD dst_unused:UNUSED_PAD src0_sel:DWORD src1_sel:WORD_1
    v_lshlrev_b32_sdwa v188, 1, v188 dst_sel:DWORD dst_unused:UNUSED_PAD src0_sel:DWORD src1_sel:WORD_1
    v_lshlrev_b32_sdwa v189, 1, v189 dst_sel:DWORD dst_unused:UNUSED_PAD src0_sel:DWORD src1_sel:WORD_1
    v_lshlrev_b32_sdwa v190, 1, v190 dst_sel:DWORD dst_unused:UNUSED_PAD src0_sel:DWORD src1_sel:WORD_1
    v_lshlrev_b32_sdwa v191, 1, v191 dst_sel:DWORD dst_unused:UNUSED_PAD src0_sel:DWORD src1_sel:WORD_1
    v_xor_b32_sdwa v2, v10, v18 dst_sel:DWORD dst_unused:UNUSED_PAD src0_sel:WORD_0 src1_sel:WORD_0
    v_perm_b32 v219, v10, v219, v12
    s_nop 0
    buffer_load_dword v168, v168, s[4:7], 0 offen
    buffer_load_dword v169, v169, s[4:7], 0 offen
    buffer_load_dword v170, v170, s[4:7], 0 offen
    buffer_load_dword v171, v171, s[4:7], 0 offen
    ds_read_u16 v184, v184 offset:64256
    ds_read_u16 v185, v185 offset:64256
    ds_read_u16 v186, v186 offset:64256
    ds_read_u16 v187, v187 offset:64256
    buffer_load_dword v172, v172, s[4:7], 0 offen
    buffer_load_dword v173, v173, s[4:7], 0 offen
    buffer_load_dword v174, v174, s[4:7], 0 offen
    buffer_load_dword v175, v175, s[4:7], 0 offen
    s_waitcnt lgkmcnt(8)
    ds_read_u16_d16_hi v188, v188 offset:64256
    ds_read_u16_d16_hi v189, v189 offset:64256
    ds_read_u16_d16_hi v190, v190 offset:64256
    ds_read_u16_d16_hi v191, v191 offset:64256
    ds_read_b64 v[216:217], v2
    s_setprio 0
    s_cbranch_vccz M_PR4
    s_setprio 1
M_PR4:
    v_exp_f32 v232, -v192
    v_exp_f32 v233, -v193
    v_exp_f32 v234, -v194
    v_exp_f32 v235, -v195
    v_exp_f32 v236, -v196
    v_exp_f32 v237, -v197
    v_exp_f32 v238, -v198
    v_exp_f32 v239, -v199
    v_exp_f32 v240, -v200
    v_exp_f32 v241, -v201
    v_exp_f32 v242, -v202
    v_exp_f32 v243, -v203
    v_exp_f32 v244, -v204
    v_exp_f32 v245, -v205
    v_exp_f32 v246, -v206
    v_exp_f32 v247, -v207
    v_pk_add_f32 v[232:233], v[232:233], 1.0 op_sel_hi:[1,0]
    v_pk_add_f32 v[234:235], v[234:235], 1.0 op_sel_hi:[1,0]
    v_pk_add_f32 v[236:237], v[236:237], 1.0 op_sel_hi:[1,0]
    v_pk_add_f32 v[238:239], v[238:239], 1.0 op_sel_hi:[1,0]
    v_pk_add_f32 v[240:241], v[240:241], 1.0 op_sel_hi:[1,0]
    v_pk_add_f32 v[242:243], v[242:243], 1.0 op_sel_hi:[1,0]
    v_pk_add_f32 v[244:245], v[244:245], 1.0 op_sel_hi:[1,0]
    v_pk_add_f32 v[246:247], v[246:247], 1.0 op_sel_hi:[1,0]
    v_rcp_f32 v232, v232
    v_rcp_f32 v233, v233
    v_rcp_f32 v234, v234
    v_rcp_f32 v235, v235
    v_rcp_f32 v236, v236
    v_rcp_f32 v237, v237
    v_rcp_f32 v238, v238
    v_rcp_f32 v239, v239
    v_rcp_f32 v240, v240
    v_rcp_f32 v241, v241
    v_rcp_f32 v242, v242
    v_rcp_f32 v243, v243
    v_rcp_f32 v244, v244
    v_rcp_f32 v245, v245
    v_rcp_f32 v246, v246
    v_rcp_f32 v247, v247
    v_pk_mul_f32 v[192:193], v[192:193], v[232:233]
    v_pk_mul_f32 v[194:195], v[194:195], v[234:235]
    v_pk_mul_f32 v[196:197], v[196:197], v[236:237]
    v_pk_mul_f32 v[198:199], v[198:199], v[238:239]
    v_pk_mul_f32 v[200:201], v[200:201], v[240:241]
    v_pk_mul_f32 v[202:203], v[202:203], v[242:243]
    v_pk_mul_f32 v[204:205], v[204:205], v[244:245]
    v_pk_mul_f32 v[206:207], v[206:207], v[246:247]
    s_waitcnt lgkmcnt(9)
    v_or_b32 v176, v176, v180
    v_or_b32 v177, v177, v181
    v_or_b32 v178, v178, v182
    v_or_b32 v179, v179, v183
    s_setprio 2
    v_cvt_pk_bf16_f32 v208, v192, v196
    v_cvt_pk_bf16_f32 v209, v193, v197
    v_cvt_pk_bf16_f32 v210, v194, v198
    v_cvt_pk_bf16_f32 v211, v195, v199
    v_mfma_f32_32x32x16_bf16 v[40:55], v[176:179], v[220:223], v[40:55]
    s_waitcnt lgkmcnt(1)
    v_or_b32 v184, v184, v188
    v_or_b32 v185, v185, v189
    v_or_b32 v186, v186, v190
    v_or_b32 v187, v187, v191
    v_cvt_pk_bf16_f32 v212, v200, v204
    v_cvt_pk_bf16_f32 v213, v201, v205
    v_cvt_pk_bf16_f32 v214, v202, v206
    v_cvt_pk_bf16_f32 v215, v203, v207
    v_mfma_f32_32x32x16_bf16 v[40:55], v[184:187], v[224:227], v[40:55]
    s_waitcnt lgkmcnt(0)
    ds_read_b128 v[232:235], v15 offset:256
    ds_read_b128 v[236:239], v15 offset:288
    ds_read_b128 v[240:243], v15 offset:320
    ds_read_b128 v[244:247], v15 offset:352
    v_mfma_f32_32x32x16_bf16 v[56:71], v[208:211], v[220:223], v[56:71]
    ds_read_b128 v[192:195], v15 offset:384
    ds_read_b128 v[196:199], v15 offset:416
    ds_read_b128 v[200:203], v15 offset:448
    ds_read_b128 v[204:207], v15 offset:480
    v_mfma_f32_32x32x16_bf16 v[56:71], v[212:215], v[224:227], v[56:71]
M_FLUSH2:
    ds_read_b64_tr_b16 v[220:221], v228 offset:8
    ds_read_b64_tr_b16 v[222:223], v229 offset:40
    ds_read_b64_tr_b16 v[224:225], v230 offset:264
    ds_read_b64_tr_b16 v[226:227], v231 offset:296
    ds_read_b128 v[228:231], v3
    s_lshr_b32 s56, s62, 2
    s_add_u32 s62, s62, 4
    v_mov_b32 v4, s62
    s_sub_u32 s10, 0, s10
    s_bitcmp1_b32 s73, s62
    s_cselect_b64 vcc, -1, 0
    s_waitcnt lgkmcnt(9)
    v_pk_mul_f32 v[180:181], v[40:41], v[232:233]
    v_pk_mul_f32 v[182:183], v[42:43], v[234:235]
    v_pk_fma_f32 v[180:181], v[44:45], v[236:237], v[180:181]
    v_pk_fma_f32 v[182:183], v[46:47], v[238:239], v[182:183]
    v_pk_fma_f32 v[180:181], v[48:49], v[240:241], v[180:181]
    v_pk_fma_f32 v[182:183], v[50:51], v[242:243], v[182:183]
    v_pk_fma_f32 v[180:181], v[52:53], v[244:245], v[180:181]
    v_pk_fma_f32 v[182:183], v[54:55], v[246:247], v[182:183]
    s_waitcnt lgkmcnt(5)
    v_pk_fma_f32 v[180:181], v[56:57], v[192:193], v[180:181]
    v_pk_fma_f32 v[182:183], v[58:59], v[194:195], v[182:183]
    v_pk_fma_f32 v[180:181], v[60:61], v[196:197], v[180:181]
    v_pk_fma_f32 v[182:183], v[62:63], v[198:199], v[182:183]
    v_pk_fma_f32 v[180:181], v[64:65], v[200:201], v[180:181]
    v_pk_fma_f32 v[182:183], v[66:67], v[202:203], v[182:183]
    v_pk_fma_f32 v[180:181], v[68:69], v[204:205], v[180:181]
    v_pk_fma_f32 v[182:183], v[70:71], v[206:207], v[182:183]
    v_pk_add_f32 v[180:181], v[180:181], v[182:183]
    s_mov_b64 exec, s[92:93]
    v_cvt_pk_bf16_f32 v128, v40, v41
    v_cvt_pk_bf16_f32 v129, v42, v43
    v_cvt_pk_bf16_f32 v130, v44, v45
    v_cvt_pk_bf16_f32 v131, v46, v47
    v_cvt_pk_bf16_f32 v132, v48, v49
    v_cvt_pk_bf16_f32 v133, v50, v51
    v_cvt_pk_bf16_f32 v134, v52, v53
    v_cvt_pk_bf16_f32 v135, v54, v55
    s_mov_b64 exec, -1
    s_waitcnt lgkmcnt(0)
    v_mfma_f32_32x32x16_bf16 v[40:55], v[176:179], v[220:223], 0
    ds_write_b32 v19, v4
    s_mov_b64 exec, s[92:93]
    v_cvt_pk_bf16_f32 v136, v56, v57
    v_cvt_pk_bf16_f32 v137, v58, v59
    v_cvt_pk_bf16_f32 v138, v60, v61
    v_cvt_pk_bf16_f32 v139, v62, v63
    v_cvt_pk_bf16_f32 v140, v64, v65
    v_cvt_pk_bf16_f32 v141, v66, v67
    v_cvt_pk_bf16_f32 v142, v68, v69
    v_cvt_pk_bf16_f32 v143, v70, v71
    s_mov_b64 exec, -1
    v_mfma_f32_32x32x16_bf16 v[56:71], v[208:211], v[220:223], 0
    s_lshl_b64 s[92:93], s[92:93], 1
    s_cmp_eq_u32 s62, 16
    s_set_gpr_idx_on s56, gpr_idx(SRC0,DST)
    v_add_f32 v22, v22, v180
    v_add_f32 v22, v22, v181
    s_set_gpr_idx_off
    v_mfma_f32_32x32x16_bf16 v[40:55], v[184:187], v[224:227], v[40:55]
    v_mfma_f32_32x32x16_bf16 v[56:71], v[212:215], v[224:227], v[56:71]
M_SEL:
    s_bitcmp1_b32 s61, 0
    s_cbranch_scc1 M_SEL1
    s_bitcmp1_b32 s63, 4
    s_cbranch_scc1 M_FULL0
    s_branch M_OTH0
M_SEL1:
    s_bitcmp1_b32 s63, 4
    s_cbranch_scc1 M_FULL1
    s_branch M_OTH1
M_LAST0:
    s_bitcmp1_b32 s63, 1
    s_cbranch_scc1 M_LH0
    v_readlane_b32 s63, v13, s61
    v_xor_b32 v18, 8, v18
    v_add_u32 v9, s10, v9
    v_lshl_add_u32 v228, v228, 16, v5
    v_lshl_add_u32 v229, v229, 16, v5
    s_waitcnt vmcnt(16)
    v_mfma_f32_32x32x16_bf16 v[192:207], v[216:219], v[124:127], v[144:159]
    ds_read_b64_tr_b16 v[220:221], v228 offset:8
    ds_read_b64_tr_b16 v[222:223], v229 offset:40
    v_lshlrev_b64 v[176:177], 16, v[144:145]
    v_lshlrev_b64 v[178:179], 16, v[146:147]
    v_lshlrev_b64 v[180:181], 16, v[148:149]
    v_lshlrev_b64 v[182:183], 16, v[150:151]
    s_lshr_b32 s75, s63, 16
    v_add_u32 v4, s75, v11
    v_mfma_f32_32x32x16_bf16 v[176:191], v[216:219], v[120:123], v[176:191]
    ds_read_b128 v[144:147], v4 offset:0
    ds_read_b128 v[148:151], v4 offset:32
    ds_read_b128 v[152:155], v4 offset:64
    ds_read_b128 v[156:159], v4 offset:96
    s_and_b32 s74, s63, 0xff00
    s_and_b32 s75, s63, 0xff00
    v_lshl_add_u64 v[2:3], v[6:7], 0, s[74:75]
    v_lshl_add_u64 v[4:5], v[8:9], 0, s[74:75]
    s_add_u32 s61, s61, 1
    ds_read_b32 v10, v2
    ds_read_b128 v[228:231], v3
    ds_read_b64 v[218:219], v4
    v_lshlrev_b32_sdwa v176, 1, v176 dst_sel:DWORD dst_unused:UNUSED_PAD src0_sel:DWORD src1_sel:WORD_1
    v_lshlrev_b32_sdwa v177, 1, v177 dst_sel:DWORD dst_unused:UNUSED_PAD src0_sel:DWORD src1_sel:WORD_1
    v_lshlrev_b32_sdwa v178, 1, v178 dst_sel:DWORD dst_unused:UNUSED_PAD src0_sel:DWORD src1_sel:WORD_1
    v_lshlrev_b32_sdwa v179, 1, v179 dst_sel:DWORD dst_unused:UNUSED_PAD src0_sel:DWORD src1_sel:WORD_1
    v_lshlrev_b32_sdwa v180, 1, v180 dst_sel:DWORD dst_unused:UNUSED_PAD src0_sel:DWORD src1_sel:WORD_1
    v_lshlrev_b32_sdwa v181, 1, v181 dst_sel:DWORD dst_unused:UNUSED_PAD src0_sel:DWORD src1_sel:WORD_1
    v_lshlrev_b32_sdwa v182, 1, v182 dst_sel:DWORD dst_unused:UNUSED_PAD src0_sel:DWORD src1_sel:WORD_1
    v_lshlrev_b32_sdwa v183, 1, v183 dst_sel:DWORD dst_unused:UNUSED_PAD src0_sel:DWORD src1_sel:WORD_1
    s_waitcnt lgkmcnt(3)
    ds_read_u16 v176, v176 offset:64256
    ds_read_u16 v177, v177 offset:64256
    ds_read_u16 v178, v178 offset:64256
    ds_read_u16 v179, v179 offset:64256
    buffer_load_dword v144, v144, s[4:7], 0 offen
    buffer_load_dword v145, v145, s[4:7], 0 offen
    buffer_load_dword v146, v146, s[4:7], 0 offen
    buffer_load_dword v147, v147, s[4:7], 0 offen
    ds_read_u16_d16_hi v180, v180 offset:64256
    ds_read_u16_d16_hi v181, v181 offset:64256
    ds_read_u16_d16_hi v182, v182 offset:64256
    ds_read_u16_d16_hi v183, v183 offset:64256
    buffer_load_dword v148, v148, s[4:7], 0 offen
    buffer_load_dword v149, v149, s[4:7], 0 offen
    buffer_load_dword v150, v150, s[4:7], 0 offen
    buffer_load_dword v151, v151, s[4:7], 0 offen
    s_waitcnt lgkmcnt(8)
    v_xor_b32_sdwa v2, v10, v18 dst_sel:DWORD dst_unused:UNUSED_PAD src0_sel:WORD_0 src1_sel:WORD_0
    v_perm_b32 v219, v10, v219, v12
    s_nop 0
    buffer_load_dword v152, v152, s[4:7], 0 offen
    buffer_load_dword v153, v153, s[4:7], 0 offen
    buffer_load_dword v154, v154, s[4:7], 0 offen
    buffer_load_dword v155, v155, s[4:7], 0 offen
    buffer_load_dword v156, v156, s[4:7], 0 offen
    buffer_load_dword v157, v157, s[4:7], 0 offen
    buffer_load_dword v158, v158, s[4:7], 0 offen
    buffer_load_dword v159, v159, s[4:7], 0 offen
    ds_read_b64 v[216:217], v2
    s_setprio 0
    s_cbranch_vccz M_PR5
    s_setprio 1
M_PR5:
    v_exp_f32 v232, -v192
    v_exp_f32 v233, -v193
    v_exp_f32 v234, -v194
    v_exp_f32 v235, -v195
    v_exp_f32 v236, -v196
    v_exp_f32 v237, -v197
    v_exp_f32 v238, -v198
    v_exp_f32 v239, -v199
    v_pk_add_f32 v[232:233], v[232:233], 1.0 op_sel_hi:[1,0]
    v_pk_add_f32 v[234:235], v[234:235], 1.0 op_sel_hi:[1,0]
    v_pk_add_f32 v[236:237], v[236:237], 1.0 op_sel_hi:[1,0]
    v_pk_add_f32 v[238:239], v[238:239], 1.0 op_sel_hi:[1,0]
    v_rcp_f32 v232, v232
    v_rcp_f32 v233, v233
    v_rcp_f32 v234, v234
    v_rcp_f32 v235, v235
    v_rcp_f32 v236, v236
    v_rcp_f32 v237, v237
    v_rcp_f32 v238, v238
    v_rcp_f32 v239, v239
    v_pk_mul_f32 v[192:193], v[192:193], v[232:233]
    v_pk_mul_f32 v[194:195], v[194:195], v[234:235]
    v_pk_mul_f32 v[196:197], v[196:197], v[236:237]
    v_pk_mul_f32 v[198:199], v[198:199], v[238:239]
    s_waitcnt lgkmcnt(1)
    v_or_b32 v176, v176, v180
    v_or_b32 v177, v177, v181
    v_or_b32 v178, v178, v182
    v_or_b32 v179, v179, v183
    s_setprio 2
    v_cvt_pk_bf16_f32 v208, v192, v196
    v_cvt_pk_bf16_f32 v209, v193, v197
    v_cvt_pk_bf16_f32 v210, v194, v198
    v_cvt_pk_bf16_f32 v211, v195, v199
    v_mfma_f32_32x32x16_bf16 v[40:55], v[176:179], v[220:223], v[40:55]
    s_waitcnt lgkmcnt(0)
    ds_read_b128 v[232:235], v15 offset:256
    ds_read_b128 v[236:239], v15 offset:288
    ds_read_b128 v[240:243], v15 offset:320
    ds_read_b128 v[244:247], v15 offset:352
    v_mfma_f32_32x32x16_bf16 v[56:71], v[208:211], v[220:223], v[56:71]
    ds_read_b128 v[192:195], v15 offset:384
    ds_read_b128 v[196:199], v15 offset:416
    ds_read_b128 v[200:203], v15 offset:448
    ds_read_b128 v[204:207], v15 offset:480
    s_branch M_FLUSH
M_LH0:
    v_readlane_b32 s63, v13, s61
    v_xor_b32 v18, 8, v18
    v_add_u32 v9, s10, v9
    v_lshl_add_u32 v228, v228, 16, v5
    v_lshl_add_u32 v229, v229, 16, v5
    v_lshl_add_u32 v230, v230, 16, v5
    v_lshl_add_u32 v231, v231, 16, v5
    s_waitcnt vmcnt(16)
    v_mfma_f32_32x32x16_bf16 v[192:207], v[216:219], v[124:127], v[144:159]
    ds_read_b64_tr_b16 v[220:221], v228 offset:8
    ds_read_b64_tr_b16 v[222:223], v229 offset:40
    ds_read_b64_tr_b16 v[224:225], v230 offset:264
    ds_read_b64_tr_b16 v[226:227], v231 offset:296
    v_lshlrev_b64 v[176:177], 16, v[144:145]
    v_lshlrev_b64 v[178:179], 16, v[146:147]
    v_lshlrev_b64 v[180:181], 16, v[148:149]
    v_lshlrev_b64 v[182:183], 16, v[150:151]
    v_lshlrev_b64 v[184:185], 16, v[152:153]
    v_lshlrev_b64 v[186:187], 16, v[154:155]
    v_lshlrev_b64 v[188:189], 16, v[156:157]
    v_lshlrev_b64 v[190:191], 16, v[158:159]
    s_lshr_b32 s75, s63, 16
    v_add_u32 v4, s75, v11
    v_mfma_f32_32x32x16_bf16 v[176:191], v[216:219], v[120:123], v[176:191]
    ds_read_b128 v[144:147], v4 offset:0
    ds_read_b128 v[148:151], v4 offset:32
    ds_read_b128 v[152:155], v4 offset:64
    ds_read_b128 v[156:159], v4 offset:96
    s_and_b32 s74, s63, 0xff00
    s_and_b32 s75, s63, 0xff00
    v_lshl_add_u64 v[2:3], v[6:7], 0, s[74:75]
    v_lshl_add_u64 v[4:5], v[8:9], 0, s[74:75]
    s_add_u32 s61, s61, 1
    ds_read_b32 v10, v2
    ds_read_b128 v[228:231], v3
    ds_read_b64 v[218:219], v4
    v_lshlrev_b32_sdwa v176, 1, v176 dst_sel:DWORD dst_unused:UNUSED_PAD src0_sel:DWORD src1_sel:WORD_1
    v_lshlrev_b32_sdwa v177, 1, v177 dst_sel:DWORD dst_unused:UNUSED_PAD src0_sel:DWORD src1_sel:WORD_1
    v_lshlrev_b32_sdwa v178, 1, v178 dst_sel:DWORD dst_unused:UNUSED_PAD src0_sel:DWORD src1_sel:WORD_1
    v_lshlrev_b32_sdwa v179, 1, v179 dst_sel:DWORD dst_unused:UNUSED_PAD src0_sel:DWORD src1_sel:WORD_1
    v_lshlrev_b32_sdwa v180, 1, v180 dst_sel:DWORD dst_unused:UNUSED_PAD src0_sel:DWORD src1_sel:WORD_1
    v_lshlrev_b32_sdwa v181, 1, v181 dst_sel:DWORD dst_unused:UNUSED_PAD src0_sel:DWORD src1_sel:WORD_1
    v_lshlrev_b32_sdwa v182, 1, v182 dst_sel:DWORD dst_unused:UNUSED_PAD src0_sel:DWORD src1_sel:WORD_1
    v_lshlrev_b32_sdwa v183, 1, v183 dst_sel:DWORD dst_unused:UNUSED_PAD src0_sel:DWORD src1_sel:WORD_1
    s_waitcnt lgkmcnt(3)
    ds_read_u16 v176, v176 offset:64256
    ds_read_u16 v177, v177 offset:64256
    ds_read_u16 v178, v178 offset:64256
    ds_read_u16 v179, v179 offset:64256
    buffer_load_dword v144, v144, s[4:7], 0 offen
    buffer_load_dword v145, v145, s[4:7], 0 offen
    buffer_load_dword v146, v146, s[4:7], 0 offen
    buffer_load_dword v147, v147, s[4:7], 0 offen
    ds_read_u16_d16_hi v180, v180 offset:64256
    ds_read_u16_d16_hi v181, v181 offset:64256
    ds_read_u16_d16_hi v182, v182 offset:64256
    ds_read_u16_d16_hi v183, v183 offset:64256
    buffer_load_dword v148, v148, s[4:7], 0 offen
    buffer_load_dword v149, v149, s[4:7], 0 offen
    buffer_load_dword v150, v150, s[4:7], 0 offen
    buffer_load_dword v151, v151, s[4:7], 0 offen
    s_waitcnt lgkmcnt(8)
    v_lshlrev_b32_sdwa v184, 1, v184 dst_sel:DWORD dst_unused:UNUSED_PAD src0_sel:DWORD src1_sel:WORD_1
    v_lshlrev_b32_sdwa v185, 1, v185 dst_sel:DWORD dst_unused:UNUSED_PAD src0_sel:DWORD src1_sel:WORD_1
    v_lshlrev_b32_sdwa v186, 1, v186 dst_sel:DWORD dst_unused:UNUSED_PAD src0_sel:DWORD src1_sel:WORD_1
    v_lshlrev_b32_sdwa v187, 1, v187 dst_sel:DWORD dst_unused:UNUSED_PAD src0_sel:DWORD src1_sel:WORD_1
    v_lshlrev_b32_sdwa v188, 1, v188 dst_sel:DWORD dst_unused:UNUSED_PAD src0_sel:DWORD src1_sel:WORD_1
    v_lshlrev_b32_sdwa v189, 1, v189 dst_sel:DWORD dst_unused:UNUSED_PAD src0_sel:DWORD src1_sel:WORD_1
    v_lshlrev_b32_sdwa v190, 1, v190 dst_sel:DWORD dst_unused:UNUSED_PAD src0_sel:DWORD src1_sel:WORD_1
    v_lshlrev_b32_sdwa v191, 1, v191 dst_sel:DWORD dst_unused:UNUSED_PAD src0_sel:DWORD src1_sel:WORD_1
    v_xor_b32_sdwa v2, v10, v18 dst_sel:DWORD dst_unused:UNUSED_PAD src0_sel:WORD_0 src1_sel:WORD_0
    v_perm_b32 v219, v10, v219, v12
    s_nop 0
    buffer_load_dword v152, v152, s[4:7], 0 offen
    buffer_load_dword v153, v153, s[4:7], 0 offen
    buffer_load_dword v154, v154, s[4:7], 0 offen
    buffer_load_dword v155, v155, s[4:7], 0 offen
    ds_read_u16 v184, v184 offset:64256
    ds_read_u16 v185, v185 offset:64256
    ds_read_u16 v186, v186 offset:64256
    ds_read_u16 v187, v187 offset:64256
    buffer_load_dword v156, v156, s[4:7], 0 offen
    buffer_load_dword v157, v157, s[4:7], 0 offen
    buffer_load_dword v158, v158, s[4:7], 0 offen
    buffer_load_dword v159, v159, s[4:7], 0 offen
    s_waitcnt lgkmcnt(8)
    ds_read_u16_d16_hi v188, v188 offset:64256
    ds_read_u16_d16_hi v189, v189 offset:64256
    ds_read_u16_d16_hi v190, v190 offset:64256
    ds_read_u16_d16_hi v191, v191 offset:64256
    ds_read_b64 v[216:217], v2
    s_setprio 0
    s_cbranch_vccz M_PR6
    s_setprio 1
M_PR6:
    v_exp_f32 v232, -v192
    v_exp_f32 v233, -v193
    v_exp_f32 v234, -v194
    v_exp_f32 v235, -v195
    v_exp_f32 v236, -v196
    v_exp_f32 v237, -v197
    v_exp_f32 v238, -v198
    v_exp_f32 v239, -v199
    v_exp_f32 v240, -v200
    v_exp_f32 v241, -v201
    v_exp_f32 v242, -v202
    v_exp_f32 v243, -v203
    v_exp_f32 v244, -v204
    v_exp_f32 v245, -v205
    v_exp_f32 v246, -v206
    v_exp_f32 v247, -v207
    v_pk_add_f32 v[232:233], v[232:233], 1.0 op_sel_hi:[1,0]
    v_pk_add_f32 v[234:235], v[234:235], 1.0 op_sel_hi:[1,0]
    v_pk_add_f32 v[236:237], v[236:237], 1.0 op_sel_hi:[1,0]
    v_pk_add_f32 v[238:239], v[238:239], 1.0 op_sel_hi:[1,0]
    v_pk_add_f32 v[240:241], v[240:241], 1.0 op_sel_hi:[1,0]
    v_pk_add_f32 v[242:243], v[242:243], 1.0 op_sel_hi:[1,0]
    v_pk_add_f32 v[244:245], v[244:245], 1.0 op_sel_hi:[1,0]
    v_pk_add_f32 v[246:247], v[246:247], 1.0 op_sel_hi:[1,0]
    v_rcp_f32 v232, v232
    v_rcp_f32 v233, v233
    v_rcp_f32 v234, v234
    v_rcp_f32 v235, v235
    v_rcp_f32 v236, v236
    v_rcp_f32 v237, v237
    v_rcp_f32 v238, v238
    v_rcp_f32 v239, v239
    v_rcp_f32 v240, v240
    v_rcp_f32 v241, v241
    v_rcp_f32 v242, v242
    v_rcp_f32 v243, v243
    v_rcp_f32 v244, v244
    v_rcp_f32 v245, v245
    v_rcp_f32 v246, v246
    v_rcp_f32 v247, v247
    v_pk_mul_f32 v[192:193], v[192:193], v[232:233]
    v_pk_mul_f32 v[194:195], v[194:195], v[234:235]
    v_pk_mul_f32 v[196:197], v[196:197], v[236:237]
    v_pk_mul_f32 v[198:199], v[198:199], v[238:239]
    v_pk_mul_f32 v[200:201], v[200:201], v[240:241]
    v_pk_mul_f32 v[202:203], v[202:203], v[242:243]
    v_pk_mul_f32 v[204:205], v[204:205], v[244:245]
    v_pk_mul_f32 v[206:207], v[206:207], v[246:247]
    s_waitcnt lgkmcnt(9)
    v_or_b32 v176, v176, v180
    v_or_b32 v177, v177, v181
    v_or_b32 v178, v178, v182
    v_or_b32 v179, v179, v183
    s_setprio 2
    v_cvt_pk_bf16_f32 v208, v192, v196
    v_cvt_pk_bf16_f32 v209, v193, v197
    v_cvt_pk_bf16_f32 v210, v194, v198
    v_cvt_pk_bf16_f32 v211, v195, v199
    v_mfma_f32_32x32x16_bf16 v[40:55], v[176:179], v[220:223], v[40:55]
    s_waitcnt lgkmcnt(1)
    v_or_b32 v184, v184, v188
    v_or_b32 v185, v185, v189
    v_or_b32 v186, v186, v190
    v_or_b32 v187, v187, v191
    v_cvt_pk_bf16_f32 v212, v200, v204
    v_cvt_pk_bf16_f32 v213, v201, v205
    v_cvt_pk_bf16_f32 v214, v202, v206
    v_cvt_pk_bf16_f32 v215, v203, v207
    v_mfma_f32_32x32x16_bf16 v[40:55], v[184:187], v[224:227], v[40:55]
    s_waitcnt lgkmcnt(0)
    ds_read_b128 v[232:235], v15 offset:256
    ds_read_b128 v[236:239], v15 offset:288
    ds_read_b128 v[240:243], v15 offset:320
    ds_read_b128 v[244:247], v15 offset:352
    v_mfma_f32_32x32x16_bf16 v[56:71], v[208:211], v[220:223], v[56:71]
    ds_read_b128 v[192:195], v15 offset:384
    ds_read_b128 v[196:199], v15 offset:416
    ds_read_b128 v[200:203], v15 offset:448
    ds_read_b128 v[204:207], v15 offset:480
    v_mfma_f32_32x32x16_bf16 v[56:71], v[212:215], v[224:227], v[56:71]
    s_branch M_FLUSH
M_LAST1:
    s_bitcmp1_b32 s63, 1
    s_cbranch_scc1 M_LH1
    v_readlane_b32 s63, v13, s61
    v_xor_b32 v18, 8, v18
    v_add_u32 v9, s10, v9
    v_lshl_add_u32 v228, v228, 16, v5
    v_lshl_add_u32 v229, v229, 16, v5
    s_waitcnt vmcnt(16)
    v_mfma_f32_32x32x16_bf16 v[192:207], v[216:219], v[124:127], v[160:175]
    ds_read_b64_tr_b16 v[220:221], v228 offset:8
    ds_read_b64_tr_b16 v[222:223], v229 offset:40
    v_lshlrev_b64 v[176:177], 16, v[160:161]
    v_lshlrev_b64 v[178:179], 16, v[162:163]
    v_lshlrev_b64 v[180:181], 16, v[164:165]
    v_lshlrev_b64 v[182:183], 16, v[166:167]
    s_lshr_b32 s75, s63, 16
    v_add_u32 v4, s75, v11
    v_mfma_f32_32x32x16_bf16 v[176:191], v[216:219], v[120:123], v[176:191]
    ds_read_b128 v[160:163], v4 offset:0
    ds_read_b128 v[164:167], v4 offset:32
    ds_read_b128 v[168:171], v4 offset:64
    ds_read_b128 v[172:175], v4 offset:96
    s_and_b32 s74, s63, 0xff00
    s_and_b32 s75, s63, 0xff00
    v_lshl_add_u64 v[2:3], v[6:7], 0, s[74:75]
    v_lshl_add_u64 v[4:5], v[8:9], 0, s[74:75]
    s_add_u32 s61, s61, 1
    ds_read_b32 v10, v2
    ds_read_b128 v[228:231], v3
    ds_read_b64 v[218:219], v4
    v_lshlrev_b32_sdwa v176, 1, v176 dst_sel:DWORD dst_unused:UNUSED_PAD src0_sel:DWORD src1_sel:WORD_1
    v_lshlrev_b32_sdwa v177, 1, v177 dst_sel:DWORD dst_unused:UNUSED_PAD src0_sel:DWORD src1_sel:WORD_1
    v_lshlrev_b32_sdwa v178, 1, v178 dst_sel:DWORD dst_unused:UNUSED_PAD src0_sel:DWORD src1_sel:WORD_1
    v_lshlrev_b32_sdwa v179, 1, v179 dst_sel:DWORD dst_unused:UNUSED_PAD src0_sel:DWORD src1_sel:WORD_1
    v_lshlrev_b32_sdwa v180, 1, v180 dst_sel:DWORD dst_unused:UNUSED_PAD src0_sel:DWORD src1_sel:WORD_1
    v_lshlrev_b32_sdwa v181, 1, v181 dst_sel:DWORD dst_unused:UNUSED_PAD src0_sel:DWORD src1_sel:WORD_1
    v_lshlrev_b32_sdwa v182, 1, v182 dst_sel:DWORD dst_unused:UNUSED_PAD src0_sel:DWORD src1_sel:WORD_1
    v_lshlrev_b32_sdwa v183, 1, v183 dst_sel:DWORD dst_unused:UNUSED_PAD src0_sel:DWORD src1_sel:WORD_1
    s_waitcnt lgkmcnt(3)
    ds_read_u16 v176, v176 offset:64256
    ds_read_u16 v177, v177 offset:64256
    ds_read_u16 v178, v178 offset:64256
    ds_read_u16 v179, v179 offset:64256
    buffer_load_dword v160, v160, s[4:7], 0 offen
    buffer_load_dword v161, v161, s[4:7], 0 offen
    buffer_load_dword v162, v162, s[4:7], 0 offen
    buffer_load_dword v163, v163, s[4:7], 0 offen
    ds_read_u16_d16_hi v180, v180 offset:64256
    ds_read_u16_d16_hi v181, v181 offset:64256
    ds_read_u16_d16_hi v182, v182 offset:64256
    ds_read_u16_d16_hi v183, v183 offset:64256
    buffer_load_dword v164, v164, s[4:7], 0 offen
    buffer_load_dword v165, v165, s[4:7], 0 offen
    buffer_load_dword v166, v166, s[4:7], 0 offen
    buffer_load_dword v167, v167, s[4:7], 0 offen
    s_waitcnt lgkmcnt(8)
    v_xor_b32_sdwa v2, v10, v18 dst_sel:DWORD dst_unused:UNUSED_PAD src0_sel:WORD_0 src1_sel:WORD_0
    v_perm_b32 v219, v10, v219, v12
    s_nop 0
    buffer_load_dword v168, v168, s[4:7], 0 offen
    buffer_load_dword v169, v169, s[4:7], 0 offen
    buffer_load_dword v170, v170, s[4:7], 0 offen
    buffer_load_dword v171, v171, s[4:7], 0 offen
    buffer_load_dword v172, v172, s[4:7], 0 offen
    buffer_load_dword v173, v173, s[4:7], 0 offen
    buffer_load_dword v174, v174, s[4:7], 0 offen
    buffer_load_dword v175, v175, s[4:7], 0 offen
    ds_read_b64 v[216:217], v2
    s_setprio 0
    s_cbranch_vccz M_PR7
    s_setprio 1
M_PR7:
    v_exp_f32 v232, -v192
    v_exp_f32 v233, -v193
    v_exp_f32 v234, -v194
    v_exp_f32 v235, -v195
    v_exp_f32 v236, -v196
    v_exp_f32 v237, -v197
    v_exp_f32 v238, -v198
    v_exp_f32 v239, -v199
    v_pk_add_f32 v[232:233], v[232:233], 1.0 op_sel_hi:[1,0]
    v_pk_add_f32 v[234:235], v[234:235], 1.0 op_sel_hi:[1,0]
    v_pk_add_f32 v[236:237], v[236:237], 1.0 op_sel_hi:[1,0]
    v_pk_add_f32 v[238:239], v[238:239], 1.0 op_sel_hi:[1,0]
    v_rcp_f32 v232, v232
    v_rcp_f32 v233, v233
    v_rcp_f32 v234, v234
    v_rcp_f32 v235, v235
    v_rcp_f32 v236, v236
    v_rcp_f32 v237, v237
    v_rcp_f32 v238, v238
    v_rcp_f32 v239, v239
    v_pk_mul_f32 v[192:193], v[192:193], v[232:233]
    v_pk_mul_f32 v[194:195], v[194:195], v[234:235]
    v_pk_mul_f32 v[196:197], v[196:197], v[236:237]
    v_pk_mul_f32 v[198:199], v[198:199], v[238:239]
    s_waitcnt lgkmcnt(1)
    v_or_b32 v176, v176, v180
    v_or_b32 v177, v177, v181
    v_or_b32 v178, v178, v182
    v_or_b32 v179, v179, v183
    s_setprio 2
    v_cvt_pk_bf16_f32 v208, v192, v196
    v_cvt_pk_bf16_f32 v209, v193, v197
    v_cvt_pk_bf16_f32 v210, v194, v198
    v_cvt_pk_bf16_f32 v211, v195, v199
    v_mfma_f32_32x32x16_bf16 v[40:55], v[176:179], v[220:223], v[40:55]
    s_waitcnt lgkmcnt(0)
    ds_read_b128 v[232:235], v15 offset:256
    ds_read_b128 v[236:239], v15 offset:288
    ds_read_b128 v[240:243], v15 offset:320
    ds_read_b128 v[244:247], v15 offset:352
    v_mfma_f32_32x32x16_bf16 v[56:71], v[208:211], v[220:223], v[56:71]
    ds_read_b128 v[192:195], v15 offset:384
    ds_read_b128 v[196:199], v15 offset:416
    ds_read_b128 v[200:203], v15 offset:448
    ds_read_b128 v[204:207], v15 offset:480
    s_branch M_FLUSH
M_LH1:
    v_readlane_b32 s63, v13, s61
    v_xor_b32 v18, 8, v18
    v_add_u32 v9, s10, v9
    v_lshl_add_u32 v228, v228, 16, v5
    v_lshl_add_u32 v229, v229, 16, v5
    v_lshl_add_u32 v230, v230, 16, v5
    v_lshl_add_u32 v231, v231, 16, v5
    s_waitcnt vmcnt(16)
    v_mfma_f32_32x32x16_bf16 v[192:207], v[216:219], v[124:127], v[160:175]
    ds_read_b64_tr_b16 v[220:221], v228 offset:8
    ds_read_b64_tr_b16 v[222:223], v229 offset:40
    ds_read_b64_tr_b16 v[224:225], v230 offset:264
    ds_read_b64_tr_b16 v[226:227], v231 offset:296
    v_lshlrev_b64 v[176:177], 16, v[160:161]
    v_lshlrev_b64 v[178:179], 16, v[162:163]
    v_lshlrev_b64 v[180:181], 16, v[164:165]
    v_lshlrev_b64 v[182:183], 16, v[166:167]
    v_lshlrev_b64 v[184:185], 16, v[168:169]
    v_lshlrev_b64 v[186:187], 16, v[170:171]
    v_lshlrev_b64 v[188:189], 16, v[172:173]
    v_lshlrev_b64 v[190:191], 16, v[174:175]
    s_lshr_b32 s75, s63, 16
    v_add_u32 v4, s75, v11
    v_mfma_f32_32x32x16_bf16 v[176:191], v[216:219], v[120:123], v[176:191]
    ds_read_b128 v[160:163], v4 offset:0
    ds_read_b128 v[164:167], v4 offset:32
    ds_read_b128 v[168:171], v4 offset:64
    ds_read_b128 v[172:175], v4 offset:96
    s_and_b32 s74, s63, 0xff00
    s_and_b32 s75, s63, 0xff00
    v_lshl_add_u64 v[2:3], v[6:7], 0, s[74:75]
    v_lshl_add_u64 v[4:5], v[8:9], 0, s[74:75]
    s_add_u32 s61, s61, 1
    ds_read_b32 v10, v2
    ds_read_b128 v[228:231], v3
    ds_read_b64 v[218:219], v4
    v_lshlrev_b32_sdwa v176, 1, v176 dst_sel:DWORD dst_unused:UNUSED_PAD src0_sel:DWORD src1_sel:WORD_1
    v_lshlrev_b32_sdwa v177, 1, v177 dst_sel:DWORD dst_unused:UNUSED_PAD src0_sel:DWORD src1_sel:WORD_1
    v_lshlrev_b32_sdwa v178, 1, v178 dst_sel:DWORD dst_unused:UNUSED_PAD src0_sel:DWORD src1_sel:WORD_1
    v_lshlrev_b32_sdwa v179, 1, v179 dst_sel:DWORD dst_unused:UNUSED_PAD src0_sel:DWORD src1_sel:WORD_1
    v_lshlrev_b32_sdwa v180, 1, v180 dst_sel:DWORD dst_unused:UNUSED_PAD src0_sel:DWORD src1_sel:WORD_1
    v_lshlrev_b32_sdwa v181, 1, v181 dst_sel:DWORD dst_unused:UNUSED_PAD src0_sel:DWORD src1_sel:WORD_1
    v_lshlrev_b32_sdwa v182, 1, v182 dst_sel:DWORD dst_unused:UNUSED_PAD src0_sel:DWORD src1_sel:WORD_1
    v_lshlrev_b32_sdwa v183, 1, v183 dst_sel:DWORD dst_unused:UNUSED_PAD src0_sel:DWORD src1_sel:WORD_1
    s_waitcnt lgkmcnt(3)
    ds_read_u16 v176, v176 offset:64256
    ds_read_u16 v177, v177 offset:64256
    ds_read_u16 v178, v178 offset:64256
    ds_read_u16 v179, v179 offset:64256
    buffer_load_dword v160, v160, s[4:7], 0 offen
    buffer_load_dword v161, v161, s[4:7], 0 offen
    buffer_load_dword v162, v162, s[4:7], 0 offen
    buffer_load_dword v163, v163, s[4:7], 0 offen
    ds_read_u16_d16_hi v180, v180 offset:64256
    ds_read_u16_d16_hi v181, v181 offset:64256
    ds_read_u16_d16_hi v182, v182 offset:64256
    ds_read_u16_d16_hi v183, v183 offset:64256
    buffer_load_dword v164, v164, s[4:7], 0 offen
    buffer_load_dword v165, v165, s[4:7], 0 offen
    buffer_load_dword v166, v166, s[4:7], 0 offen
    buffer_load_dword v167, v167, s[4:7], 0 offen
    s_waitcnt lgkmcnt(8)
    v_lshlrev_b32_sdwa v184, 1, v184 dst_sel:DWORD dst_unused:UNUSED_PAD src0_sel:DWORD src1_sel:WORD_1
    v_lshlrev_b32_sdwa v185, 1, v185 dst_sel:DWORD dst_unused:UNUSED_PAD src0_sel:DWORD src1_sel:WORD_1
    v_lshlrev_b32_sdwa v186, 1, v186 dst_sel:DWORD dst_unused:UNUSED_PAD src0_sel:DWORD src1_sel:WORD_1
    v_lshlrev_b32_sdwa v187, 1, v187 dst_sel:DWORD dst_unused:UNUSED_PAD src0_sel:DWORD src1_sel:WORD_1
    v_lshlrev_b32_sdwa v188, 1, v188 dst_sel:DWORD dst_unused:UNUSED_PAD src0_sel:DWORD src1_sel:WORD_1
    v_lshlrev_b32_sdwa v189, 1, v189 dst_sel:DWORD dst_unused:UNUSED_PAD src0_sel:DWORD src1_sel:WORD_1
    v_lshlrev_b32_sdwa v190, 1, v190 dst_sel:DWORD dst_unused:UNUSED_PAD src0_sel:DWORD src1_sel:WORD_1
    v_lshlrev_b32_sdwa v191, 1, v191 dst_sel:DWORD dst_unused:UNUSED_PAD src0_sel:DWORD src1_sel:WORD_1
    v_xor_b32_sdwa v2, v10, v18 dst_sel:DWORD dst_unused:UNUSED_PAD src0_sel:WORD_0 src1_sel:WORD_0
    v_perm_b32 v219, v10, v219, v12
    s_nop 0
    buffer_load_dword v168, v168, s[4:7], 0 offen
    buffer_load_dword v169, v169, s[4:7], 0 offen
    buffer_load_dword v170, v170, s[4:7], 0 offen
    buffer_load_dword v171, v171, s[4:7], 0 offen
    ds_read_u16 v184, v184 offset:64256
    ds_read_u16 v185, v185 offset:64256
    ds_read_u16 v186, v186 offset:64256
    ds_read_u16 v187, v187 offset:64256
    buffer_load_dword v172, v172, s[4:7], 0 offen
    buffer_load_dword v173, v173, s[4:7], 0 offen
    buffer_load_dword v174, v174, s[4:7], 0 offen
    buffer_load_dword v175, v175, s[4:7], 0 offen
    s_waitcnt lgkmcnt(8)
    ds_read_u16_d16_hi v188, v188 offset:64256
    ds_read_u16_d16_hi v189, v189 offset:64256
    ds_read_u16_d16_hi v190, v190 offset:64256
    ds_read_u16_d16_hi v191, v191 offset:64256
    ds_read_b64 v[216:217], v2
    s_setprio 0
    s_cbranch_vccz M_PR8
    s_setprio 1
M_PR8:
    v_exp_f32 v232, -v192
    v_exp_f32 v233, -v193
    v_exp_f32 v234, -v194
    v_exp_f32 v235, -v195
    v_exp_f32 v236, -v196
    v_exp_f32 v237, -v197
    v_exp_f32 v238, -v198
    v_exp_f32 v239, -v199
    v_exp_f32 v240, -v200
    v_exp_f32 v241, -v201
    v_exp_f32 v242, -v202
    v_exp_f32 v243, -v203
    v_exp_f32 v244, -v204
    v_exp_f32 v245, -v205
    v_exp_f32 v246, -v206
    v_exp_f32 v247, -v207
    v_pk_add_f32 v[232:233], v[232:233], 1.0 op_sel_hi:[1,0]
    v_pk_add_f32 v[234:235], v[234:235], 1.0 op_sel_hi:[1,0]
    v_pk_add_f32 v[236:237], v[236:237], 1.0 op_sel_hi:[1,0]
    v_pk_add_f32 v[238:239], v[238:239], 1.0 op_sel_hi:[1,0]
    v_pk_add_f32 v[240:241], v[240:241], 1.0 op_sel_hi:[1,0]
    v_pk_add_f32 v[242:243], v[242:243], 1.0 op_sel_hi:[1,0]
    v_pk_add_f32 v[244:245], v[244:245], 1.0 op_sel_hi:[1,0]
    v_pk_add_f32 v[246:247], v[246:247], 1.0 op_sel_hi:[1,0]
    v_rcp_f32 v232, v232
    v_rcp_f32 v233, v233
    v_rcp_f32 v234, v234
    v_rcp_f32 v235, v235
    v_rcp_f32 v236, v236
    v_rcp_f32 v237, v237
    v_rcp_f32 v238, v238
    v_rcp_f32 v239, v239
    v_rcp_f32 v240, v240
    v_rcp_f32 v241, v241
    v_rcp_f32 v242, v242
    v_rcp_f32 v243, v243
    v_rcp_f32 v244, v244
    v_rcp_f32 v245, v245
    v_rcp_f32 v246, v246
    v_rcp_f32 v247, v247
    v_pk_mul_f32 v[192:193], v[192:193], v[232:233]
    v_pk_mul_f32 v[194:195], v[194:195], v[234:235]
    v_pk_mul_f32 v[196:197], v[196:197], v[236:237]
    v_pk_mul_f32 v[198:199], v[198:199], v[238:239]
    v_pk_mul_f32 v[200:201], v[200:201], v[240:241]
    v_pk_mul_f32 v[202:203], v[202:203], v[242:243]
    v_pk_mul_f32 v[204:205], v[204:205], v[244:245]
    v_pk_mul_f32 v[206:207], v[206:207], v[246:247]
    s_waitcnt lgkmcnt(9)
    v_or_b32 v176, v176, v180
    v_or_b32 v177, v177, v181
    v_or_b32 v178, v178, v182
    v_or_b32 v179, v179, v183
    s_setprio 2
    v_cvt_pk_bf16_f32 v208, v192, v196
    v_cvt_pk_bf16_f32 v209, v193, v197
    v_cvt_pk_bf16_f32 v210, v194, v198
    v_cvt_pk_bf16_f32 v211, v195, v199
    v_mfma_f32_32x32x16_bf16 v[40:55], v[176:179], v[220:223], v[40:55]
    s_waitcnt lgkmcnt(1)
    v_or_b32 v184, v184, v188
    v_or_b32 v185, v185, v189
    v_or_b32 v186, v186, v190
    v_or_b32 v187, v187, v191
    v_cvt_pk_bf16_f32 v212, v200, v204
    v_cvt_pk_bf16_f32 v213, v201, v205
    v_cvt_pk_bf16_f32 v214, v202, v206
    v_cvt_pk_bf16_f32 v215, v203, v207
    v_mfma_f32_32x32x16_bf16 v[40:55], v[184:187], v[224:227], v[40:55]
    s_waitcnt lgkmcnt(0)
    ds_read_b128 v[232:235], v15 offset:256
    ds_read_b128 v[236:239], v15 offset:288
    ds_read_b128 v[240:243], v15 offset:320
    ds_read_b128 v[244:247], v15 offset:352
    v_mfma_f32_32x32x16_bf16 v[56:71], v[208:211], v[220:223], v[56:71]
    ds_read_b128 v[192:195], v15 offset:384
    ds_read_b128 v[196:199], v15 offset:416
    ds_read_b128 v[200:203], v15 offset:448
    ds_read_b128 v[204:207], v15 offset:480
    v_mfma_f32_32x32x16_bf16 v[56:71], v[212:215], v[224:227], v[56:71]
M_FLUSH:
    s_add_u32 s55, s62, 4
    s_and_b32 s55, s55, 12
    s_set_gpr_idx_on s55, gpr_idx(SRC0)
    v_mov_b32 v120, v104
    v_mov_b32 v121, v105
    v_mov_b32 v124, v106
    v_mov_b32 v125, v107
    s_set_gpr_idx_off
    s_lshr_b32 s56, s62, 2
    s_add_u32 s62, s62, 4
    v_mov_b32 v4, s62
    s_sub_u32 s10, 0, s10
    s_bitcmp1_b32 s73, s62
    s_cselect_b64 vcc, -1, 0
    s_waitcnt lgkmcnt(4)
    v_pk_mul_f32 v[180:181], v[40:41], v[232:233]
    v_pk_mul_f32 v[182:183], v[42:43], v[234:235]
    v_pk_fma_f32 v[180:181], v[44:45], v[236:237], v[180:181]
    v_pk_fma_f32 v[182:183], v[46:47], v[238:239], v[182:183]
    v_pk_fma_f32 v[180:181], v[48:49], v[240:241], v[180:181]
    v_pk_fma_f32 v[182:183], v[50:51], v[242:243], v[182:183]
    v_pk_fma_f32 v[180:181], v[52:53], v[244:245], v[180:181]
    v_pk_fma_f32 v[182:183], v[54:55], v[246:247], v[182:183]
    s_waitcnt lgkmcnt(0)
    v_pk_fma_f32 v[180:181], v[56:57], v[192:193], v[180:181]
    v_pk_fma_f32 v[182:183], v[58:59], v[194:195], v[182:183]
    v_pk_fma_f32 v[180:181], v[60:61], v[196:197], v[180:181]
    v_pk_fma_f32 v[182:183], v[62:63], v[198:199], v[182:183]
    v_pk_fma_f32 v[180:181], v[64:65], v[200:201], v[180:181]
    v_pk_fma_f32 v[182:183], v[66:67], v[202:203], v[182:183]
    v_pk_fma_f32 v[180:181], v[68:69], v[204:205], v[180:181]
    v_pk_fma_f32 v[182:183], v[70:71], v[206:207], v[182:183]
    v_pk_add_f32 v[180:181], v[180:181], v[182:183]
    s_mov_b64 exec, s[92:93]
    v_cvt_pk_bf16_f32 v128, v40, v41
    v_cvt_pk_bf16_f32 v129, v42, v43
    v_cvt_pk_bf16_f32 v130, v44, v45
    v_cvt_pk_bf16_f32 v131, v46, v47
    v_cvt_pk_bf16_f32 v132, v48, v49
    v_cvt_pk_bf16_f32 v133, v50, v51
    v_cvt_pk_bf16_f32 v134, v52, v53
    v_cvt_pk_bf16_f32 v135, v54, v55
    s_mov_b64 exec, -1
    v_mfma_f32_32x32x16_bf16 v[40:55], v[248:251], v[248:251], 0
    ds_write_b32 v19, v4
    s_mov_b64 exec, s[92:93]
    v_cvt_pk_bf16_f32 v136, v56, v57
    v_cvt_pk_bf16_f32 v137, v58, v59
    v_cvt_pk_bf16_f32 v138, v60, v61
    v_cvt_pk_bf16_f32 v139, v62, v63
    v_cvt_pk_bf16_f32 v140, v64, v65
    v_cvt_pk_bf16_f32 v141, v66, v67
    v_cvt_pk_bf16_f32 v142, v68, v69
    v_cvt_pk_bf16_f32 v143, v70, v71
    s_mov_b64 exec, -1
    v_mfma_f32_32x32x16_bf16 v[56:71], v[248:251], v[248:251], 0
    s_lshl_b64 s[92:93], s[92:93], 1
    s_cmp_eq_u32 s62, 16
    s_set_gpr_idx_on s56, gpr_idx(SRC0,DST)
    v_add_f32 v22, v22, v180
    v_add_f32 v22, v22, v181
    s_set_gpr_idx_off
    s_cbranch_scc0 M_SEL
M_END:
    s_setprio 0
    v_xor_b32 v208, 4, v19
    v_lshlrev_b32 v214, 4, v1
    s_mul_i32 s55, s54, 10752
    ds_read_b32 v215, v208
    v_mov_b64 v[220:221], v[22:23]
    v_mov_b64 v[222:223], v[24:25]
    s_add_u32 s55, s55, s64
    v_add_u32 v209, s55, v214
    v_permlane32_swap_b32 v220, v221
    v_permlane32_swap_b32 v222, v223
    v_lshl_add_u32 v211, v1, 2, s55
    v_add_f32 v220, v220, v221
    v_add_f32 v221, v222, v223
    v_mov_b32 v222, 20
    s_cmp_eq_u32 s54, 0
    s_cbranch_scc1 K_SW
    v_swap_b32 v220, v221
K_SW:
    s_mov_b32 s57, 0
K_PW1:
    s_waitcnt lgkmcnt(0)
    v_readfirstlane_b32 s55, v215
    s_cmp_ge_u32 s55, s11
    s_cbranch_scc1 K_PW1X
    ds_read_b32 v215, v208
    s_add_u32 s57, s57, 1
    s_cmp_gt_u32 s57, 6400000
    s_cbranch_scc0 K_PW1
    s_endpgm
K_PW1X:
    ds_write_b128 v209, v[128:131] offset:0
    ds_write_b128 v209, v[132:135] offset:1024
    ds_write_b128 v209, v[136:139] offset:2048
    ds_write_b128 v209, v[140:143] offset:3072
    ds_write_b32 v211, v221 offset:4096
    ds_write_b32 v19, v222
    s_movk_i32 s55, 4096
    buffer_load_dwordx4 v[176:179], v214, s[12:15], 0 offen offset:0
    buffer_load_dwordx4 v[180:183], v214, s[12:15], 0 offen offset:1024
    buffer_load_dwordx4 v[184:187], v214, s[12:15], 0 offen offset:2048
    buffer_load_dwordx4 v[188:191], v214, s[12:15], 0 offen offset:3072
    buffer_load_dwordx4 v[192:195], v214, s[12:15], s55 offen offset:0
    buffer_load_dwordx4 v[196:199], v214, s[12:15], s55 offen offset:1024
    buffer_load_dwordx4 v[200:203], v214, s[12:15], s55 offen offset:2048
    buffer_load_dwordx4 v[204:207], v214, s[12:15], s55 offen offset:3072
    s_waitcnt vmcnt(8)
    v_mfma_f32_32x32x16_bf16 v[72:87], v[128:131], v[144:147], v[72:87]
    v_lshlrev_b32 v40, 16, v26
    v_lshlrev_b32 v56, 16, v32
    v_and_b32 v41, 0xffff0000, v26
    v_and_b32 v57, 0xffff0000, v32
    s_xor_b32 s57, s54, 1
    s_mul_i32 s55, s57, 10752
    v_mfma_f32_32x32x16_bf16 v[88:103], v[128:131], v[160:163], v[88:103]
    v_lshlrev_b32 v42, 16, v27
    v_lshlrev_b32 v58, 16, v33
    v_and_b32 v43, 0xffff0000, v27
    s_add_u32 s55, s55, s64
    v_add_u32 v212, s55, v214
    v_mfma_f32_32x32x16_bf16 v[72:87], v[132:135], v[148:151], v[72:87]
    v_and_b32 v59, 0xffff0000, v33
    v_lshlrev_b32 v44, 16, v28
    v_lshlrev_b32 v60, 16, v34
    v_lshl_add_u32 v214, v1, 2, s55
    v_lshrrev_b32 v222, 5, v1
    v_lshl_add_u32 v222, s54, 1, v222
    v_mfma_f32_32x32x16_bf16 v[88:103], v[132:135], v[164:167], v[88:103]
    v_and_b32 v45, 0xffff0000, v28
    v_and_b32 v61, 0xffff0000, v34
    v_lshlrev_b32 v46, 16, v29
    v_bfe_u32 v223, v1, 2, 3
    v_lshl_add_u32 v223, v223, 2, v222
    v_mfma_f32_32x32x16_bf16 v[72:87], v[136:139], v[152:155], v[72:87]
    v_lshlrev_b32 v62, 16, v35
    v_and_b32 v47, 0xffff0000, v29
    v_and_b32 v63, 0xffff0000, v35
    v_lshlrev_b32 v48, 16, v30
    v_lshl_add_u32 v223, v223, 2, s53
    v_and_b32 v224, 3, v1
    v_mfma_f32_32x32x16_bf16 v[88:103], v[136:139], v[168:171], v[88:103]
    v_lshlrev_b32 v64, 16, v36
    v_and_b32 v49, 0xffff0000, v30
    v_and_b32 v65, 0xffff0000, v36
    v_xor_b32 v222, v222, v224
    v_cmp_gt_u32 vcc, 98, v223
    v_cmp_ne_u32 s[94:95], 0, v222
    v_mfma_f32_32x32x16_bf16 v[72:87], v[140:143], v[156:159], v[72:87]
    v_lshlrev_b32 v50, 16, v31
    v_lshlrev_b32 v66, 16, v37
    v_and_b32 v51, 0xffff0000, v31
    v_mad_u32_u24 v216, v223, 3, v222
    v_add_lshl_u32 v222, v216, v223, 2
    v_mfma_f32_32x32x16_bf16 v[88:103], v[140:143], v[172:175], v[88:103]
    v_and_b32 v67, 0xffff0000, v37
    v_lshlrev_b32 v52, 16, v38
    v_lshlrev_b32 v68, 16, v39
    s_and_b64 s[94:95], s[94:95], vcc
    ds_read_b32 v222, v222 offset:1148
    ds_read_b32 v215, v208
    s_mov_b32 s57, 0
K_PW2:
    s_waitcnt lgkmcnt(0)
    v_readfirstlane_b32 s55, v215
    s_cmp_ge_u32 s55, 20
    s_cbranch_scc1 K_PW2X
    ds_read_b32 v215, v208
    s_add_u32 s57, s57, 1
    s_cmp_gt_u32 s57, 6400000
    s_cbranch_scc0 K_PW2
    s_endpgm
K_PW2X:
    ds_read_b128 v[232:235], v212 offset:0
    ds_read_b128 v[236:239], v212 offset:1024
    ds_read_b128 v[240:243], v212 offset:2048
    ds_read_b128 v[244:247], v212 offset:3072
    ds_read_b32 v221, v214 offset:4096
    s_waitcnt vmcnt(0)
    s_waitcnt lgkmcnt(4)
    v_mfma_f32_32x32x16_bf16 v[72:87], v[232:235], v[176:179], v[72:87]
    s_waitcnt lgkmcnt(3)
    v_mfma_f32_32x32x16_bf16 v[72:87], v[236:239], v[180:183], v[72:87]
    s_waitcnt lgkmcnt(2)
    v_mfma_f32_32x32x16_bf16 v[72:87], v[240:243], v[184:187], v[72:87]
    s_waitcnt lgkmcnt(1)
    v_mfma_f32_32x32x16_bf16 v[72:87], v[244:247], v[188:191], v[72:87]
    s_or_b32 s55, s68, s69
    s_cmp_eq_u32 s55, 0
    s_cbranch_scc1 K_FINAL
    v_mfma_f32_32x32x16_bf16 v[88:103], v[232:235], v[192:195], v[88:103]
    v_mfma_f32_32x32x16_bf16 v[88:103], v[236:239], v[196:199], v[88:103]
    v_mfma_f32_32x32x16_bf16 v[88:103], v[240:243], v[200:203], v[88:103]
    v_mfma_f32_32x32x16_bf16 v[88:103], v[244:247], v[204:207], v[88:103]
    s_mov_b32 s60, 4
    s_cmp_lg_u32 s68, 0
    s_cbranch_scc1 K_AGAIN
    s_add_u32 s58, s58, 256
    s_mov_b64 s[84:85], 0
    s_mov_b64 s[86:87], 0
    s_mov_b64 s[88:89], 0
    s_mov_b64 s[90:91], 0
K_AGAIN:
    s_waitcnt vmcnt(0) lgkmcnt(0)
    s_barrier
    s_branch K_ROUND
K_FINAL:
    v_mfma_f32_32x32x16_bf16 v[88:103], v[232:235], v[192:195], v[88:103]
    s_mov_b32 s76, 0x3f317218
    s_mul_i32 s55, s2, 588
    s_sub_u32 s55, s55, 2
    s_waitcnt lgkmcnt(0)
    v_add_f32 v220, v220, v221
    v_fmac_f32 v222, s76, v220
    v_cvt_pk_bf16_f32 v222, v222, v222
    v_lshl_add_u32 v216, v216, 1, s55
    v_mfma_f32_32x32x16_bf16 v[88:103], v[236:239], v[196:199], v[88:103]
    s_mov_b64 exec, s[94:95]
    buffer_store_short v222, v216, s[16:19], 0 offen sc0 sc1
    s_mov_b64 exec, -1
    v_mul_f32 v72, s76, v72
    v_lshlrev_b32_sdwa v72, 1, v72 dst_sel:DWORD dst_unused:UNUSED_PAD src0_sel:DWORD src1_sel:WORD_1
    v_mul_f32 v73, s76, v73
    v_lshlrev_b32_sdwa v73, 1, v73 dst_sel:DWORD dst_unused:UNUSED_PAD src0_sel:DWORD src1_sel:WORD_1
    v_mul_f32 v74, s76, v74
    v_lshlrev_b32_sdwa v74, 1, v74 dst_sel:DWORD dst_unused:UNUSED_PAD src0_sel:DWORD src1_sel:WORD_1
    v_mul_f32 v75, s76, v75
    v_lshlrev_b32_sdwa v75, 1, v75 dst_sel:DWORD dst_unused:UNUSED_PAD src0_sel:DWORD src1_sel:WORD_1
    v_mfma_f32_32x32x16_bf16 v[88:103], v[240:243], v[200:203], v[88:103]
    ds_read_u16_d16_hi v72, v72 offset:64256
    ds_read_u16_d16_hi v73, v73 offset:64256
    ds_read_u16_d16_hi v74, v74 offset:64256
    ds_read_u16_d16_hi v75, v75 offset:64256
    v_mul_f32 v76, s76, v76
    v_lshlrev_b32_sdwa v76, 1, v76 dst_sel:DWORD dst_unused:UNUSED_PAD src0_sel:DWORD src1_sel:WORD_1
    v_mul_f32 v77, s76, v77
    v_lshlrev_b32_sdwa v77, 1, v77 dst_sel:DWORD dst_unused:UNUSED_PAD src0_sel:DWORD src1_sel:WORD_1
    v_mul_f32 v78, s76, v78
    v_lshlrev_b32_sdwa v78, 1, v78 dst_sel:DWORD dst_unused:UNUSED_PAD src0_sel:DWORD src1_sel:WORD_1
    v_mul_f32 v79, s76, v79
    v_lshlrev_b32_sdwa v79, 1, v79 dst_sel:DWORD dst_unused:UNUSED_PAD src0_sel:DWORD src1_sel:WORD_1
    v_mfma_f32_32x32x16_bf16 v[88:103], v[244:247], v[204:207], v[88:103]
    ds_read_u16_d16_hi v76, v76 offset:64256
    ds_read_u16_d16_hi v77, v77 offset:64256
    ds_read_u16_d16_hi v78, v78 offset:64256
    ds_read_u16_d16_hi v79, v79 offset:64256
    v_mul_f32 v80, s76, v80
    v_lshlrev_b32_sdwa v80, 1, v80 dst_sel:DWORD dst_unused:UNUSED_PAD src0_sel:DWORD src1_sel:WORD_1
    v_mul_f32 v81, s76, v81
    v_lshlrev_b32_sdwa v81, 1, v81 dst_sel:DWORD dst_unused:UNUSED_PAD src0_sel:DWORD src1_sel:WORD_1
    v_mul_f32 v82, s76, v82
    v_lshlrev_b32_sdwa v82, 1, v82 dst_sel:DWORD dst_unused:UNUSED_PAD src0_sel:DWORD src1_sel:WORD_1
    v_mul_f32 v83, s76, v83
    v_lshlrev_b32_sdwa v83, 1, v83 dst_sel:DWORD dst_unused:UNUSED_PAD src0_sel:DWORD src1_sel:WORD_1
    v_mul_f32 v84, s76, v84
    v_lshlrev_b32_sdwa v84, 1, v84 dst_sel:DWORD dst_unused:UNUSED_PAD src0_sel:DWORD src1_sel:WORD_1
    s_or_b32 s55, s2, s52
    s_cmp_lg_u32 s55, 0
    ds_read_u16_d16_hi v80, v80 offset:64256
    ds_read_u16_d16_hi v81, v81 offset:64256
    ds_read_u16_d16_hi v82, v82 offset:64256
    ds_read_u16_d16_hi v83, v83 offset:64256
    ds_read_u16_d16_hi v84, v84 offset:64256
    s_cbranch_scc1 K_NONON
    v_mov_b32 v220, 12615680
    v_mov_b32 v221, s71
    s_mov_b64 exec, 1
    global_store_dword v220, v221, s[22:23] sc0 sc1
    s_mov_b64 exec, -1
K_NONON:
    v_exp_f32 v232, -v88
    v_exp_f32 v233, -v89
    v_exp_f32 v234, -v90
    v_exp_f32 v235, -v91
    v_exp_f32 v236, -v92
    v_exp_f32 v237, -v93
    v_pk_add_f32 v[232:233], v[232:233], 1.0 op_sel_hi:[1,0]
    v_pk_add_f32 v[234:235], v[234:235], 1.0 op_sel_hi:[1,0]
    v_pk_add_f32 v[236:237], v[236:237], 1.0 op_sel_hi:[1,0]
    v_rcp_f32 v232, v232
    v_rcp_f32 v233, v233
    v_rcp_f32 v234, v234
    v_rcp_f32 v235, v235
    v_rcp_f32 v236, v236
    v_rcp_f32 v237, v237
    v_pk_mul_f32 v[88:89], v[88:89], v[232:233]
    v_pk_mul_f32 v[90:91], v[90:91], v[234:235]
    v_pk_mul_f32 v[92:93], v[92:93], v[236:237]
    s_waitcnt lgkmcnt(0)
    v_pk_fma_f32 v[40:41], v[72:73], s[76:77], v[40:41] op_sel_hi:[1,0,1]
    v_pk_fma_f32 v[56:57], v[88:89], s[76:77], v[56:57] op_sel_hi:[1,0,1]
    v_cvt_pk_bf16_f32 v40, v40, v56
    v_cvt_pk_bf16_f32 v41, v41, v57
    buffer_store_short v40, v14, s[28:31], 0 offen offset:0 sc0 sc1
    buffer_store_short_d16_hi v40, v14, s[28:31], 0 offen offset:64 sc0 sc1
    buffer_store_short v41, v14, s[28:31], 0 offen offset:1024 sc0 sc1
    buffer_store_short_d16_hi v41, v14, s[28:31], 0 offen offset:1088 sc0 sc1
    v_pk_fma_f32 v[42:43], v[74:75], s[76:77], v[42:43] op_sel_hi:[1,0,1]
    v_pk_fma_f32 v[58:59], v[90:91], s[76:77], v[58:59] op_sel_hi:[1,0,1]
    v_cvt_pk_bf16_f32 v42, v42, v58
    v_cvt_pk_bf16_f32 v43, v43, v59
    buffer_store_short v42, v14, s[28:31], 0 offen offset:2048 sc0 sc1
    buffer_store_short_d16_hi v42, v14, s[28:31], 0 offen offset:2112 sc0 sc1
    buffer_store_short v43, v14, s[28:31], 0 offen offset:3072 sc0 sc1
    buffer_store_short_d16_hi v43, v14, s[28:31], 0 offen offset:3136 sc0 sc1
    v_pk_fma_f32 v[44:45], v[76:77], s[76:77], v[44:45] op_sel_hi:[1,0,1]
    v_pk_fma_f32 v[60:61], v[92:93], s[76:77], v[60:61] op_sel_hi:[1,0,1]
    v_cvt_pk_bf16_f32 v44, v44, v60
    v_cvt_pk_bf16_f32 v45, v45, v61
    buffer_store_short v44, v14, s[28:31], s65 offen offset:0 sc0 sc1
    buffer_store_short_d16_hi v44, v14, s[28:31], s65 offen offset:64 sc0 sc1
    buffer_store_short v45, v14, s[28:31], s65 offen offset:1024 sc0 sc1
    buffer_store_short_d16_hi v45, v14, s[28:31], s65 offen offset:1088 sc0 sc1
    v_exp_f32 v232, -v94
    v_exp_f32 v233, -v95
    v_exp_f32 v234, -v96
    v_exp_f32 v235, -v97
    v_exp_f32 v236, -v98
    v_exp_f32 v237, -v99
    v_exp_f32 v238, -v100
    v_pk_add_f32 v[232:233], v[232:233], 1.0 op_sel_hi:[1,0]
    v_pk_add_f32 v[234:235], v[234:235], 1.0 op_sel_hi:[1,0]
    v_pk_add_f32 v[236:237], v[236:237], 1.0 op_sel_hi:[1,0]
    v_pk_add_f32 v[238:239], v[238:239], 1.0 op_sel_hi:[1,0]
    v_rcp_f32 v232, v232
    v_rcp_f32 v233, v233
    v_rcp_f32 v234, v234
    v_rcp_f32 v235, v235
    v_rcp_f32 v236, v236
    v_rcp_f32 v237, v237
    v_rcp_f32 v238, v238
    v_pk_mul_f32 v[94:95], v[94:95], v[232:233]
    v_pk_mul_f32 v[96:97], v[96:97], v[234:235]
    v_pk_mul_f32 v[98:99], v[98:99], v[236:237]
    v_pk_mul_f32 v[100:101], v[100:101], v[238:239]
    v_pk_fma_f32 v[46:47], v[78:79], s[76:77], v[46:47] op_sel_hi:[1,0,1]
    v_pk_fma_f32 v[62:63], v[94:95], s[76:77], v[62:63] op_sel_hi:[1,0,1]
    v_cvt_pk_bf16_f32 v46, v46, v62
    v_cvt_pk_bf16_f32 v47, v47, v63
    buffer_store_short v46, v14, s[28:31], s65 offen offset:2048 sc0 sc1
    buffer_store_short_d16_hi v46, v14, s[28:31], s65 offen offset:2112 sc0 sc1
    buffer_store_short v47, v14, s[28:31], s65 offen offset:3072 sc0 sc1
    buffer_store_short_d16_hi v47, v14, s[28:31], s65 offen offset:3136 sc0 sc1
    v_pk_fma_f32 v[48:49], v[80:81], s[76:77], v[48:49] op_sel_hi:[1,0,1]
    v_pk_fma_f32 v[64:65], v[96:97], s[76:77], v[64:65] op_sel_hi:[1,0,1]
    v_cvt_pk_bf16_f32 v48, v48, v64
    v_cvt_pk_bf16_f32 v49, v49, v65
    buffer_store_short v48, v14, s[28:31], s66 offen offset:0 sc0 sc1
    buffer_store_short_d16_hi v48, v14, s[28:31], s66 offen offset:64 sc0 sc1
    buffer_store_short v49, v14, s[28:31], s66 offen offset:1024 sc0 sc1
    buffer_store_short_d16_hi v49, v14, s[28:31], s66 offen offset:1088 sc0 sc1
    v_pk_fma_f32 v[50:51], v[82:83], s[76:77], v[50:51] op_sel_hi:[1,0,1]
    v_pk_fma_f32 v[66:67], v[98:99], s[76:77], v[66:67] op_sel_hi:[1,0,1]
    v_cvt_pk_bf16_f32 v50, v50, v66
    v_cvt_pk_bf16_f32 v51, v51, v67
    buffer_store_short v50, v14, s[28:31], s66 offen offset:2048 sc0 sc1
    buffer_store_short_d16_hi v50, v14, s[28:31], s66 offen offset:2112 sc0 sc1
    buffer_store_short v51, v14, s[28:31], s66 offen offset:3072 sc0 sc1
    buffer_store_short_d16_hi v51, v14, s[28:31], s66 offen offset:3136 sc0 sc1
    v_pk_fma_f32 v[52:53], v[84:85], s[76:77], v[52:53] op_sel_hi:[1,0,1]
    v_pk_fma_f32 v[68:69], v[100:101], s[76:77], v[68:69] op_sel_hi:[1,0,1]
    v_cvt_pk_bf16_f32 v52, v52, v68
    buffer_store_short v52, v14, s[28:31], s67 offen offset:0 sc0 sc1
    buffer_store_short_d16_hi v52, v14, s[28:31], s67 offen offset:64 sc0 sc1
K_END:
    s_endpgm
.p2align 8
.type silu_table,@object
silu_table:
.quad 0x3000200010000,0x5000500040003,0x8000800070006,0xb000a000a0009,0xe000d000d000c,0x1100100010000f,0x14001300120012,0x17001600150015
.quad 0x1a001900180017,0x1c001c001b001a,0x1f001f001e001d,0x22002200210020,0x25002400240023,0x28002700270026,0x2b002a00290029,0x2e002d002c002c
.quad 0x310030002f002f,0x34003300320031,0x36003600350034,0x39003900380037,0x3c003c003b003a,0x3f003e003e003d,0x42004100410040,0x45004400430043
.quad 0x48004700460046,0x4b004a00490048,0x4e004d004c004b,0x500050004f004e,0x53005300520051,0x56005500550054,0x59005800580057,0x5c005b005b005a
.quad 0x5f005e005d005d,0x62006100600060,0x65006400630062,0x68006700660065,0x6a006a00690068,0x6d006d006c006b,0x70006f006f006e,0x73007200720071
.quad 0x76007500740074,0x79007800770077,0x7c007b007a007a,0x7f007e007d007c,0x8100810080007f,0x84008400830082,0x87008700860085,0x8a008900890088
.quad 0x8d008c008c008b,0x90008f008e008e,0x93009200910091,0x96009500940094,0x99009800970096,0x9b009b009a0099,0x9e009e009d009c,0xa100a000a0009f
.quad 0xa400a300a300a2,0xa700a600a600a5,0xaa00a900a800a8,0xad00ac00ab00ab,0xb000af00ae00ad,0xb300b200b100b0,0xb500b500b400b3,0xb800b800b700b6
.quad 0xbe00bc00bb00b9,0xc300c200c100bf,0xc900c800c600c5,0xcf00ce00cc00cb,0xd500d300d200d0,0xdb00d900d800d6,0xe000df00dd00dc,0xe600e500e300e2
.quad 0xec00ea00e900e8,0xf200f000ef00ed,0xf700f600f500f3,0xfd00fc00fa00f9,0x1010101010000ff,0x104010401030102,0x107010701060105,0x10a010901090108
.quad 0x10d010c010c010b,0x110010f010e010e,0x113011201110111,0x116011501140114,0x119011801170116,0x11b011b011a0119,0x11e011e011d011c,0x12101200120011f
.quad 0x124012301230122,0x127012601260125,0x12a012901280128,0x12d012c012b012b,0x130012f012e012d,0x133013201310130,0x135013501340133,0x138013801370136
.quad 0x13e013c013b0139,0x14301420141013f,0x149014801460145,0x14f014e014c014b,0x155015301520150,0x15b015901580156,0x160015f015d015c,0x166016501630162
.quad 0x16c016a01690168,0x1720170016f016d,0x177017601750173,0x17d017c017a0179,0x18101810180017f,0x184018401830182,0x187018701860185,0x18a018901890188
.quad 0x18d018c018c018b,0x190018f018e018e,0x193019201910191,0x196019501940194,0x199019801970196,0x19b019b019a0199,0x19e019e019d019c,0x1a101a001a0019f
.quad 0x1a401a301a301a2,0x1a701a601a601a5,0x1aa01a901a801a8,0x1ad01ac01ab01ab,0x1b001af01ae01ad,0x1b301b201b101b0,0x1b501b501b401b3,0x1b801b801b701b6
.quad 0x37be37bc37bb37b9,0x37c337c237c137bf,0x37c937c837c637c5,0x37cf37ce37cc37cb,0x37d537d337d237d0,0x37db37d937d837d6,0x37e037df37dd37dc,0x37e637e537e337e2
.quad 0x37ec37ea37e937e8,0x37f237f037ef37ed,0x37f737f637f537f3,0x37fd37fc37fa37f9,0x38013801380037ff,0x3804380438033802,0x3807380738063805,0x380a380938093808
.quad 0x380d380c380c380b,0x3810380f380e380e,0x3813381238113811,0x3816381538143814,0x3819381838173816,0x381b381b381a3819,0x381e381e381d381c,0x382138213820381f
.quad 0x3824382338233822,0x3827382638263825,0x382a382938283828,0x382d382c382b382b,0x3830382f382e382d,0x3833383238313830,0x3835383538343833,0x3838383838373836
.quad 0x383e383c383b3839,0x384338423841383f,0x3849384838463845,0x384f384e384c384b,0x3855385338523850,0x385b385938583856,0x3860385f385d385c,0x3866386538633862
.quad 0x386c386a38693868,0x38723870386f386d,0x3877387638753873,0x387d387c387a3879,0x388138813880387f,0x3884388438833882,0x3887388738863885,0x388a388938893888
.quad 0x388d388c388c388b,0x3890388f388e388e,0x3893389238913891,0x3896389538943894,0x3899389838973896,0x389b389b389a3899,0x389e389e389d389c,0x38a138a138a0389f
.quad 0x38a438a338a338a2,0x38a738a638a638a5,0x38aa38a938a838a8,0x38ad38ac38ab38ab,0x38b038af38ae38ad,0x38b338b238b138b0,0x38b538b538b438b3,0x38b838b838b738b6
.quad 0x38be38bc38bb38b9,0x38c338c238c138bf,0x38c938c838c638c5,0x38cf38ce38cc38cb,0x38d538d338d238d0,0x38db38d938d838d6,0x38e038df38dd38dc,0x38e638e538e338e2
.quad 0x38ec38ea38e938e8,0x38f238f038ef38ed,0x38f738f638f538f3,0x38fd38fc38fa38f9,0x39013901390038ff,0x3904390439033902,0x3907390739063905,0x390a390939093908
.quad 0x390d390c390c390b,0x3910390f390e390e,0x3913391239113911,0x3916391539143914,0x3919391839173916,0x391b391b391a3919,0x391e391e391d391c,0x392139213920391f
.quad 0x3924392339233922,0x3927392639263925,0x392a392939283928,0x392d392c392b392b,0x3930392f392e392e,0x3933393239313930,0x3935393539343933,0x3938393839373936
.quad 0x393e393c393b3939,0x394439423941393f,0x3949394839463945,0x394f394e394c394b,0x3955395339523950,0x395b395939583956,0x3960395f395d395c,0x3966396539633962
.quad 0x396c396a39693968,0x39723970396f396d,0x3977397639753973,0x397d397c397a3979,0x398239813980397f,0x3984398439833982,0x3987398739863985,0x398a398939893988
.quad 0x398d398c398c398b,0x3990398f398e398e,0x3993399239913991,0x3996399539943994,0x3999399839973996,0x399b399b399a3999,0x399e399e399d399c,0x39a139a139a0399f
.quad 0x39a439a339a339a2,0x39a739a639a639a5,0x39aa39a939a839a8,0x39ad39ac39ab39ab,0x39b039af39ae39ae,0x39b339b239b139b0,0x39b539b539b439b3,0x39b839b839b739b6
.quad 0xb7beb7bcb7bbb7b9,0xb7c3b7c2b7c1b7bf,0xb7c9b7c8b7c6b7c5,0xb7cfb7ceb7ccb7cb,0xb7d5b7d3b7d2b7d0,0xb7dbb7d9b7d8b7d6,0xb7e0b7dfb7ddb7dc,0xb7e6b7e5b7e3b7e2
.quad 0xb7ecb7eab7e9b7e8,0xb7f2b7f0b7efb7ed,0xb7f7b7f6b7f5b7f3,0xb7fdb7fcb7fab7f9,0xb801b801b800b7ff,0xb804b804b803b802,0xb807b807b806b805,0xb80ab809b809b808
.quad 0xb80db80cb80cb80b,0xb810b80fb80eb80e,0xb813b812b811b811,0xb816b815b814b814,0xb819b818b817b816,0xb81bb81bb81ab819,0xb81eb81eb81db81c,0xb821b820b820b81f
.quad 0xb824b823b823b822,0xb827b826b826b825,0xb82ab829b828b828,0xb82db82cb82bb82b,0xb830b82fb82eb82d,0xb833b832b831b830,0xb835b835b834b833,0xb838b838b837b836
.quad 0xb83eb83cb83bb839,0xb843b842b841b83f,0xb849b848b846b845,0xb84fb84eb84cb84b,0xb855b853b852b850,0xb85bb859b858b856,0xb860b85fb85db85c,0xb866b865b863b862
.quad 0xb86cb86ab869b868,0xb872b870b86fb86d,0xb877b876b875b873,0xb87db87cb87ab879,0xb881b881b880b87f,0xb884b884b883b882,0xb887b887b886b885,0xb88ab889b889b888
.quad 0xb88db88cb88cb88b,0xb890b88fb88eb88e,0xb893b892b891b891,0xb896b895b894b894,0xb899b898b897b896,0xb89bb89bb89ab899,0xb89eb89eb89db89c,0xb8a1b8a0b8a0b89f
.quad 0xb8a4b8a3b8a3b8a2,0xb8a7b8a6b8a6b8a5,0xb8aab8a9b8a8b8a8,0xb8adb8acb8abb8ab,0xb8b0b8afb8aeb8ad,0xb8b3b8b2b8b1b8b0,0xb8b5b8b5b8b4b8b3,0xb8b8b8b8b8b7b8b6
.quad 0xb8beb8bcb8bbb8b9,0xb8c3b8c2b8c1b8bf,0xb8c9b8c8b8c6b8c5,0xb8cfb8ceb8ccb8cb,0xb8d5b8d3b8d2b8d0,0xb8dbb8d9b8d8b8d6,0xb8e0b8dfb8ddb8dc,0xb8e6b8e5b8e3b8e2
.quad 0xb8ecb8eab8e9b8e8,0xb8f2b8f0b8efb8ed,0xb8f7b8f6b8f5b8f3,0xb8fdb8fcb8fab8f9,0xb901b901b900b8ff,0xb904b904b903b902,0xb907b907b906b905,0xb90ab909b909b908
.quad 0xb90db90cb90cb90b,0xb910b90fb90eb90e,0xb913b912b911b911,0xb916b915b914b914,0xb919b918b917b916,0xb91bb91bb91ab919,0xb91eb91eb91db91c,0xb921b920b920b91f
.quad 0xb924b923b923b922,0xb927b926b926b925,0xb92ab929b928b928,0xb92db92cb92bb92b,0xb930b92fb92eb92d,0xb933b932b931b930,0xb935b935b934b933,0xb938b938b937b936
.quad 0xb93eb93cb93bb939,0xb943b942b941b93f,0xb949b948b946b945,0xb94fb94eb94cb94b,0xb955b953b952b950,0xb95bb959b958b956,0xb960b95fb95db95c,0xb966b965b963b962
.quad 0xb96cb96ab969b968,0xb972b970b96fb96d,0xb977b976b974b973,0xb97db97cb97ab979,0xb981b981b980b97f,0xb984b984b983b982,0xb987b987b986b985,0xb98ab989b989b988
.quad 0xb98db98cb98cb98b,0xb990b98fb98eb98e,0xb993b992b991b991,0xb996b995b994b993,0xb999b998b997b996,0xb99bb99bb99ab999,0xb99eb99eb99db99c,0xb9a1b9a0b9a0b99f
.quad 0xb9a4b9a3b9a3b9a2,0xb9a7b9a6b9a6b9a5,0xb9aab9a9b9a8b9a8,0xb9adb9acb9abb9ab,0xb9b0b9afb9aeb9ad,0xb9b2b9b2b9b1b9b0,0xb9b5b9b5b9b4b9b3,0xb9b8b9b8b9b7b9b6
.quad 0xb9beb9bcb9bbb9b9,0xb9c3b9c2b9c1b9bf,0xb9c9b9c8b9c6b9c5,0xb9cfb9ceb9ccb9cb,0xb9d5b9d3b9d2b9d0,0xb9dbb9d9b9d8b9d6,0xb9e0b9dfb9ddb9dc,0xb9e6b9e5b9e3b9e2
.quad 0xb9ecb9eab9e9b9e7,0xb9f2b9f0b9efb9ed,0xb9f7b9f6b9f4b9f3,0xb9fdb9fcb9fab9f9,0xba01ba01ba00b9ff,0xba04ba04ba03ba02,0xba07ba06ba06ba05,0xba0aba09ba09ba08
.quad 0xba0dba0cba0cba0b,0xba10ba0fba0eba0e,0xba13ba12ba11ba11,0xba16ba15ba14ba13,0xba19ba18ba17ba16,0xba1bba1bba1aba19,0xba1eba1eba1dba1c,0xba21ba20ba20ba1f
.quad 0xba24ba23ba23ba22,0xba27ba26ba25ba25,0xba2aba29ba28ba28,0xba2dba2cba2bba2b,0xba30ba2fba2eba2d,0xba32ba32ba31ba30,0xba35ba35ba34ba33,0xba38ba37ba37ba36
.quad 0xba3eba3cba3bba39,0xba43ba42ba41ba3f,0xba49ba48ba46ba45,0xba4fba4dba4cba4b,0xba55ba53ba52ba50,0xba5aba59ba58ba56,0xba60ba5fba5dba5c,0xba66ba65ba63ba62
.quad 0xba6cba6aba69ba67,0xba71ba70ba6fba6d,0xba77ba76ba74ba73,0xba7dba7cba7aba79,0xba81ba81ba80ba7e,0xba84ba84ba83ba82,0xba87ba86ba86ba85,0xba8aba89ba89ba88
.quad 0xba8dba8cba8bba8b,0xba90ba8fba8eba8e,0xba93ba92ba91ba91,0xba96ba95ba94ba93,0xba98ba98ba97ba96,0xba9bba9bba9aba99,0xba9eba9dba9dba9c,0xbaa1baa0baa0ba9f
.quad 0xbaa4baa3baa3baa2,0xbaa7baa6baa5baa5,0xbaaabaa9baa8baa8,0xbaadbaacbaabbaaa,0xbaafbaafbaaebaad,0xbab2bab2bab1bab0,0xbab5bab5bab4bab3,0xbab8bab7bab7bab6
.quad 0xbabebabcbabbbab9,0xbac3bac2bac0babf,0xbac9bac8bac6bac5,0xbacfbacdbaccbaca,0xbad5bad3bad2bad0,0xbadabad9bad7bad6,0xbae0badfbaddbadc,0xbae6bae4bae3bae2
.quad 0xbaecbaeabae9bae7,0xbaf1baf0baeebaed,0xbaf7baf6baf4baf3,0xbafdbafbbafabaf9,0xbb01bb01bb00bafe,0xbb04bb03bb03bb02,0xbb07bb06bb06bb05,0xbb0abb09bb08bb08
.quad 0xbb0dbb0cbb0bbb0b,0xbb10bb0fbb0ebb0e,0xbb13bb12bb11bb10,0xbb15bb15bb14bb13,0xbb18bb18bb17bb16,0xbb1bbb1abb1abb19,0xbb1ebb1dbb1dbb1c,0xbb21bb20bb20bb1f
.quad 0xbb24bb23bb22bb22,0xbb27bb26bb25bb25,0xbb2abb29bb28bb27,0xbb2cbb2cbb2bbb2a,0xbb2fbb2fbb2ebb2d,0xbb32bb31bb31bb30,0xbb35bb34bb34bb33,0xbb38bb37bb37bb36
.quad 0xbb3dbb3cbb3abb39,0xbb43bb42bb40bb3f,0xbb49bb47bb46bb45,0xbb4fbb4dbb4cbb4a,0xbb54bb53bb51bb50,0xbb5abb59bb57bb56,0xbb60bb5ebb5dbb5b,0xbb66bb64bb63bb61
.quad 0xbb6bbb6abb68bb67,0xbb71bb70bb6ebb6d,0xbb77bb75bb74bb72,0xbb7dbb7bbb7abb78,0xbb81bb80bb7fbb7e,0xbb84bb83bb83bb82,0xbb87bb86bb85bb85,0xbb8abb89bb88bb88
.quad 0xbb8dbb8cbb8bbb8a,0xbb8fbb8fbb8ebb8d,0xbb92bb92bb91bb90,0xbb95bb94bb94bb93,0xbb98bb97bb97bb96,0xbb9bbb9abb9abb99,0xbb9ebb9dbb9cbb9c,0xbba1bba0bb9fbb9f
.quad 0xbba4bba3bba2bba1,0xbba6bba6bba5bba4,0xbba9bba9bba8bba7,0xbbacbbabbbabbbaa,0xbbafbbaebbaebbad,0xbbb2bbb1bbb0bbb0,0xbbb5bbb4bbb3bbb3,0xbbb8bbb7bbb6bbb5
.quad 0x39be39bc39bb39b9,0x39c439c239c139bf,0x39c939c839c639c5,0x39cf39ce39cc39cb,0x39d539d339d239d1,0x39db39d939d839d6,0x39e039df39de39dc,0x39e639e539e339e2
.quad 0x39ec39eb39e939e8,0x39f239f039ef39ed,0x39f839f639f539f3,0x39fd39fc39fa39f9,0x3a023a013a0039ff,0x3a043a043a033a02,0x3a073a073a063a05,0x3a0a3a093a093a08
.quad 0x3a0d3a0c3a0c3a0b,0x3a103a0f3a0f3a0e,0x3a133a123a113a11,0x3a163a153a143a14,0x3a193a183a173a16,0x3a1c3a1b3a1a3a19,0x3a1e3a1e3a1d3a1c,0x3a213a213a203a1f
.quad 0x3a243a233a233a22,0x3a273a263a263a25,0x3a2a3a293a293a28,0x3a2d3a2c3a2b3a2b,0x3a303a2f3a2e3a2e,0x3a333a323a313a30,0x3a363a353a343a33,0x3a383a383a373a36
.quad 0x3a3e3a3c3a3b3a39,0x3a443a423a413a3f,0x3a493a483a463a45,0x3a4f3a4e3a4c3a4b,0x3a553a533a523a51,0x3a5b3a593a583a56,0x3a603a5f3a5e3a5c,0x3a663a653a633a62
.quad 0x3a6c3a6b3a693a68,0x3a723a703a6f3a6d,0x3a783a763a753a73,0x3a7d3a7c3a7a3a79,0x3a823a813a803a7f,0x3a843a843a833a82,0x3a873a873a863a85,0x3a8a3a8a3a893a88
.quad 0x3a8d3a8c3a8c3a8b,0x3a903a8f3a8f3a8e,0x3a933a923a913a91,0x3a963a953a943a94,0x3a993a983a973a97,0x3a9c3a9b3a9a3a99,0x3a9e3a9e3a9d3a9c,0x3aa13aa13aa03a9f
.quad 0x3aa43aa43aa33aa2,0x3aa73aa63aa63aa5,0x3aaa3aa93aa93aa8,0x3aad3aac3aab3aab,0x3ab03aaf3aae3aae,0x3ab33ab23ab13ab1,0x3ab63ab53ab43ab3,0x3ab83ab83ab73ab6
.quad 0x3abe3abc3abb3aba,0x3ac43ac23ac13abf,0x3ac93ac83ac73ac5,0x3acf3ace3acc3acb,0x3ad53ad43ad23ad1,0x3adb3ad93ad83ad6,0x3ae13adf3ade3adc,0x3ae63ae53ae33ae2
.quad 0x3aec3aeb3ae93ae8,0x3af23af13aef3aee,0x3af83af63af53af3,0x3afe3afc3afb3af9,0x3b023b013b003aff,0x3b053b043b033b02,0x3b073b073b063b05,0x3b0a3b0a3b093b08
.quad 0x3b0d3b0d3b0c3b0b,0x3b103b0f3b0f3b0e,0x3b133b123b123b11,0x3b163b153b143b14,0x3b193b183b173b17,0x3b1c3b1b3b1a3b1a,0x3b1f3b1e3b1d3b1c,0x3b213b213b203b1f
.quad 0x3b243b243b233b22,0x3b273b273b263b25,0x3b2a3b293b293b28,0x3b2d3b2c3b2c3b2b,0x3b303b2f3b2f3b2e,0x3b333b323b313b31,0x3b363b353b343b34,0x3b393b383b373b36
.quad 0x3b3e3b3d3b3b3b3a,0x3b443b423b413b40,0x3b4a3b483b473b45,0x3b4f3b4e3b4d3b4b,0x3b553b543b523b51,0x3b5b3b5a3b583b57,0x3b613b5f3b5e3b5d,0x3b673b653b643b62
.quad 0x3b6c3b6b3b6a3b68,0x3b723b713b6f3b6e,0x3b783b773b753b74,0x3b7e3b7c3b7b3b7a,0x3b823b813b803b7f,0x3b853b843b833b83,0x3b883b873b863b85,0x3b8b3b8a3b893b88
.quad 0x3b8d3b8d3b8c3b8b,0x3b903b903b8f3b8e,0x3b933b933b923b91,0x3b963b953b953b94,0x3b993b983b983b97,0x3b9c3b9b3b9b3b9a,0x3b9f3b9e3b9d3b9d,0x3ba23ba13ba03ba0
.quad 0x3ba53ba43ba33ba2,0x3ba83ba73ba63ba5,0x3baa3baa3ba93ba8,0x3bad3bad3bac3bab,0x3bb03bb03baf3bae,0x3bb33bb23bb23bb1,0x3bb63bb53bb53bb4,0x3bb93bb83bb83bb7
.quad 0x3bbe3bbd3bbc3bba,0x3bc43bc33bc13bc0,0x3bca3bc93bc73bc6,0x3bd03bce3bcd3bcc,0x3bd63bd43bd33bd1,0x3bdc3bda3bd93bd7,0x3be13be03bde3bdd,0x3be73be63be43be3
.quad 0x3bed3bec3bea3be9,0x3bf33bf13bf03bef,0x3bf93bf73bf63bf4,0x3bff3bfd3bfc3bfa,0x3c023c013c013c00,0x3c053c043c043c03,0x3c083c073c073c06,0x3c0b3c0a3c093c09
.quad 0x3c0e3c0d3c0c3c0c,0x3c113c103c0f3c0f,0x3c143c133c123c12,0x3c173c163c153c14,0x3c1a3c193c183c17,0x3c1c3c1c3c1b3c1a,0x3c1f3c1f3c1e3c1d,0x3c223c223c213c20
.quad 0x3c253c253c243c23,0x3c283c273c273c26,0x3c2b3c2a3c2a3c29,0x3c2e3c2d3c2d3c2c,0x3c313c303c2f3c2f,0x3c343c333c323c32,0x3c373c363c353c35,0x3c3a3c393c383c38
.quad 0x3c3f3c3e3c3c3c3b,0x3c453c443c423c41,0x3c4b3c4a3c483c47,0x3c513c4f3c4e3c4c,0x3c573c553c543c52,0x3c5d3c5b3c5a3c58,0x3c623c613c603c5e,0x3c683c673c653c64
.quad 0x3c6e3c6d3c6b3c6a,0x3c743c733c713c70,0x3c7a3c793c773c76,0x3c803c7e3c7d3c7b,0x3c833c823c813c81,0x3c863c853c843c84,0x3c893c883c873c87,0x3c8c3c8b3c8a3c8a
.quad 0x3c8f3c8e3c8d3c8c,0x3c923c913c903c8f,0x3c953c943c933c92,0x3c983c973c963c95,0x3c9b3c9a3c993c98,0x3c9d3c9d3c9c3c9b,0x3ca03ca03c9f3c9e,0x3ca33ca33ca23ca1
.quad 0x3ca63ca63ca53ca4,0x3ca93ca93ca83ca7,0x3cac3cac3cab3caa,0x3caf3caf3cae3cad,0x3cb23cb23cb13cb0,0x3cb53cb43cb43cb3,0x3cb83cb73cb73cb6,0x3cbb3cba3cba3cb9
.quad 0x3cc13cbf3cbe3cbc,0x3cc73cc53cc43cc2,0x3ccd3ccb3cca3cc8,0x3cd33cd13cd03cce,0x3cd93cd73cd63cd4,0x3cdf3cdd3cdc3cda,0x3ce53ce33ce23ce0,0x3ceb3ce93ce83ce6
.quad 0x3cf13cef3cee3cec,0x3cf73cf53cf43cf2,0x3cfd3cfb3cfa3cf8,0x3d013d013d003cfe,0x3d043d043d033d02,0x3d073d073d063d05,0x3d0a3d0a3d093d08,0x3d0d3d0d3d0c3d0b
.quad 0x3d103d103d0f3d0e,0x3d133d133d123d11,0x3d163d163d153d14,0x3d193d193d183d17,0x3d1d3d1c3d1b3d1a,0x3d203d1f3d1e3d1d,0x3d233d223d213d20,0x3d263d253d243d23
.quad 0x3d293d283d273d26,0x3d2c3d2b3d2a3d29,0x3d2f3d2e3d2d3d2c,0x3d323d313d303d30,0x3d353d343d333d33,0x3d383d373d363d36,0x3d3b3d3a3d393d39,0x3d3e3d3d3d3d3d3c
.quad 0x3d443d423d413d3f,0x3d4a3d483d473d45,0x3d503d4f3d4d3d4b,0x3d563d553d533d52,0x3d5c3d5b3d593d58,0x3d633d613d603d5e,0x3d693d673d663d64,0x3d6f3d6e3d6c3d6a
.quad 0x3d753d743d723d71,0x3d7c3d7a3d783d77,0x3d813d803d7f3d7d,0x3d843d833d823d82,0x3d873d863d863d85,0x3d8a3d8a3d893d88,0x3d8d3d8d3d8c3d8b,0x3d913d903d8f3d8e
.quad 0x3d943d933d923d91,0x3d973d963d953d95,0x3d9a3d993d983d98,0x3d9d3d9c3d9c3d9b,0x3da03da03d9f3d9e,0x3da43da33da23da1,0x3da73da63da53da4,0x3daa3da93da83da8
.quad 0x3dad3dac3dac3dab,0x3db03db03daf3dae,0x3db43db33db23db1,0x3db73db63db53db4,0x3dba3db93db83db8,0x3dbd3dbd3dbc3dbb,0x3dc13dc03dbf3dbe,0x3dc43dc33dc23dc1
.quad 0xbbbdbbbcbbbabbb9,0xbbc3bbc1bbc0bbbe,0xbbc8bbc7bbc6bbc4,0xbbcebbcdbbcbbbca,0xbbd4bbd2bbd1bbd0,0xbbdabbd8bbd7bbd5,0xbbdfbbdebbdcbbdb,0xbbe5bbe4bbe2bbe1
.quad 0xbbebbbe9bbe8bbe6,0xbbf0bbefbbeebbec,0xbbf6bbf5bbf3bbf2,0xbbfcbbfabbf9bbf8,0xbc01bc00bbffbbfd,0xbc04bc03bc02bc01,0xbc06bc06bc05bc04,0xbc09bc09bc08bc07
.quad 0xbc0cbc0bbc0bbc0a,0xbc0fbc0ebc0ebc0d,0xbc12bc11bc10bc10,0xbc15bc14bc13bc13,0xbc18bc17bc16bc15,0xbc1abc1abc19bc18,0xbc1dbc1dbc1cbc1b,0xbc20bc1fbc1fbc1e
.quad 0xbc23bc22bc22bc21,0xbc26bc25bc24bc24,0xbc29bc28bc27bc27,0xbc2cbc2bbc2abc29,0xbc2ebc2ebc2dbc2c,0xbc31bc30bc30bc2f,0xbc34bc33bc33bc32,0xbc37bc36bc35bc35
.quad 0xbc3cbc3bbc39bc38,0xbc42bc40bc3fbc3e,0xbc48bc46bc45bc43,0xbc4dbc4cbc4abc49,0xbc53bc51bc50bc4f,0xbc59bc57bc56bc54,0xbc5ebc5dbc5bbc5a,0xbc64bc62bc61bc60
.quad 0xbc6abc68bc67bc65,0xbc6fbc6ebc6cbc6b,0xbc75bc73bc72bc71,0xbc7abc79bc78bc76,0xbc80bc7fbc7dbc7c,0xbc83bc82bc81bc81,0xbc86bc85bc84bc84,0xbc89bc88bc87bc86
.quad 0xbc8bbc8bbc8abc89,0xbc8ebc8dbc8dbc8c,0xbc91bc90bc90bc8f,0xbc94bc93bc92bc92,0xbc97bc96bc95bc94,0xbc99bc99bc98bc97,0xbc9cbc9cbc9bbc9a,0xbc9fbc9ebc9ebc9d
.quad 0xbca2bca1bca0bca0,0xbca5bca4bca3bca3,0xbca7bca7bca6bca5,0xbcaabcaabca9bca8,0xbcadbcacbcacbcab,0xbcb0bcafbcaebcae,0xbcb3bcb2bcb1bcb1,0xbcb5bcb5bcb4bcb3
.quad 0xbcbbbcb9bcb8bcb6,0xbcc0bcbfbcbdbcbc,0xbcc6bcc4bcc3bcc2,0xbccbbccabcc9bcc7,0xbcd1bcd0bccebccd,0xbcd7bcd5bcd4bcd2,0xbcdcbcdbbcd9bcd8,0xbce2bce0bcdfbcdd
.quad 0xbce7bce6bce4bce3,0xbcedbcebbceabce9,0xbcf2bcf1bcefbcee,0xbcf8bcf6bcf5bcf4,0xbcfdbcfcbcfbbcf9,0xbd01bd01bd00bcff,0xbd04bd03bd03bd02,0xbd07bd06bd06bd05
.quad 0xbd0abd09bd08bd08,0xbd0cbd0cbd0bbd0a,0xbd0fbd0ebd0ebd0d,0xbd12bd11bd11bd10,0xbd15bd14bd13bd13,0xbd17bd17bd16bd15,0xbd1abd19bd19bd18,0xbd1dbd1cbd1bbd1b
.quad 0xbd20bd1fbd1ebd1e,0xbd22bd22bd21bd20,0xbd25bd24bd24bd23,0xbd28bd27bd26bd26,0xbd2abd2abd29bd28,0xbd2dbd2cbd2cbd2b,0xbd30bd2fbd2ebd2e,0xbd33bd32bd31bd31
.quad 0xbd38bd36bd35bd34,0xbd3dbd3cbd3abd39,0xbd42bd41bd40bd3e,0xbd48bd46bd45bd44,0xbd4dbd4cbd4abd49,0xbd52bd51bd50bd4e,0xbd58bd56bd55bd54,0xbd5dbd5cbd5abd59
.quad 0xbd62bd61bd60bd5e,0xbd68bd66bd65bd64,0xbd6dbd6cbd6abd69,0xbd72bd71bd70bd6e,0xbd78bd76bd75bd74,0xbd7dbd7cbd7abd79,0xbd81bd80bd80bd7e,0xbd84bd83bd82bd82
.quad 0xbd86bd86bd85bd84,0xbd89bd88bd88bd87,0xbd8cbd8bbd8abd8a,0xbd8ebd8dbd8dbd8c,0xbd91bd90bd8fbd8f,0xbd93bd93bd92bd91,0xbd96bd95bd95bd94,0xbd98bd98bd97bd97
.quad 0xbd9bbd9abd9abd99,0xbd9ebd9dbd9cbd9c,0xbda0bd9fbd9fbd9e,0xbda3bda2bda1bda1,0xbda5bda5bda4bda3,0xbda8bda7bda6bda6,0xbdaabdaabda9bda8,0xbdadbdacbdacbdab
.quad 0xbdb2bdb0bdafbdae,0xbdb7bdb5bdb4bdb3,0xbdbcbdbabdb9bdb8,0xbdc1bdbfbdbebdbd,0xbdc5bdc4bdc3bdc2,0xbdcabdc9bdc8bdc7,0xbdcfbdcebdcdbdcc,0xbdd4bdd3bdd2bdd1
.quad 0xbdd9bdd8bdd7bdd5,0xbddebdddbddcbdda,0xbde3bde2bde0bddf,0xbde8bde6bde5bde4,0xbdecbdebbdeabde9,0xbdf1bdf0bdefbdee,0xbdf6bdf5bdf3bdf2,0xbdfbbdf9bdf8bdf7
.quad 0xbdffbdfebdfdbdfc,0xbe02be01be01be00,0xbe04be04be03be03,0xbe07be06be05be05,0xbe09be08be08be07,0xbe0bbe0bbe0abe09,0xbe0dbe0dbe0cbe0c,0xbe10be0fbe0fbe0e
.quad 0xbe12be11be11be10,0xbe14be14be13be13,0xbe16be16be15be15,0xbe19be18be18be17,0xbe1bbe1abe1abe19,0xbe1dbe1dbe1cbe1b,0xbe1fbe1fbe1ebe1e,0xbe21be21be20be20
.quad 0xbe25be24be23be22,0xbe2abe29be28be27,0xbe2ebe2dbe2cbe2b,0xbe32be31be30be2f,0xbe36be35be34be33,0xbe3abe39be38be37,0xbe3fbe3ebe3dbe3b,0xbe43be42be41be40
.quad 0xbe47be46be45be44,0xbe4abe49be49be48,0xbe4ebe4dbe4cbe4b,0xbe52be51be50be4f,0xbe56be55be54be53,0xbe5abe59be58be57,0xbe5ebe5dbe5cbe5b,0xbe61be60be5fbe5e
.quad 0xbe65be64be63be62,0xbe68be68be67be66,0xbe6cbe6bbe6abe69,0xbe70be6fbe6ebe6d,0xbe73be72be71be70,0xbe76be76be75be74,0xbe7abe79be78be77,0xbe7dbe7cbe7bbe7b
.quad 0xbe80be80be7fbe7e,0xbe82be81be81be81,0xbe83be83be83be82,0xbe85be85be84be84,0xbe87be86be86be85,0xbe88be88be87be87,0xbe8abe89be89be89,0xbe8bbe8bbe8abe8a
.quad 0xbe8ebe8dbe8dbe8c,0xbe91be90be8fbe8f,0xbe94be93be92be92,0xbe96be96be95be94,0xbe99be98be98be97,0xbe9cbe9bbe9abe9a,0xbe9ebe9ebe9dbe9c,0xbea1bea0be9fbe9f
.quad 0xbea3bea2bea2bea1,0xbea5bea5bea4bea4,0xbea8bea7bea6bea6,0xbeaabea9bea9bea8,0xbeacbeabbeabbeaa,0xbeaebeadbeadbeac,0xbeb0beafbeafbeae,0xbeb2beb1beb1beb0
.quad 0xbeb3beb3beb2beb2,0xbeb5beb5beb4beb4,0xbeb7beb6beb6beb5,0xbeb8beb8beb7beb7,0xbebabeb9beb9beb9,0xbebbbebbbebbbeba,0xbebdbebcbebcbebc,0xbebebebebebdbebd
.quad 0xbebfbebfbebfbebe,0xbec0bec0bec0bec0,0xbec2bec1bec1bec1,0xbec3bec2bec2bec2,0xbec4bec4bec3bec3,0xbec5bec5bec4bec4,0xbec6bec5bec5bec5,0xbec7bec6bec6bec6
.quad 0xbec8bec8bec7bec7,0xbec9bec9bec9bec8,0xbecbbecabecabeca,0xbeccbecbbecbbecb,0xbeccbeccbeccbecc,0xbecdbecdbecdbecd,0xbecdbecdbecdbecd,0xbecebecebecebecd
.quad 0xbecebecebecebece,0xbecebecebecebece,0xbecdbecdbecebece,0xbecdbecdbecdbecd,0xbecdbecdbecdbecd,0xbeccbeccbeccbecc,0xbecbbecbbeccbecc,0xbecabecabecbbecb
.quad 0xbec9becabecabeca,0xbec8bec8bec9bec9,0xbec7bec7bec8bec8,0xbec6bec6bec6bec7,0xbec4bec5bec5bec5,0xbec3bec3bec4bec4,0xbec1bec2bec2bec2,0xbec0bec0bec0bec1
.quad 0xbebebebebebfbebf,0xbebcbebdbebdbebd,0xbebabebbbebbbebc,0xbeb8beb9beb9beba,0xbeb6beb7beb7beb8,0xbeb4beb5beb5beb6,0xbeb2beb3beb3beb4,0xbeb0beb1beb1beb2
.quad 0x3dca3dc83dc73dc5,0x3dd03dcf3dcd3dcc,0x3dd73dd53dd43dd2,0x3dde3ddc3dda3dd9,0x3de43de23de13ddf,0x3deb3de93de73de6,0x3df13df03dee3dec,0x3df83df63df53df3
.quad 0x3dff3dfd3dfb3dfa,0x3e033e023e013e00,0x3e063e053e043e04,0x3e093e093e083e07,0x3e0d3e0c3e0b3e0a,0x3e103e0f3e0e3e0e,0x3e143e133e123e11,0x3e173e163e153e14
.quad 0x3e1a3e1a3e193e18,0x3e1e3e1d3e1c3e1b,0x3e213e203e203e1f,0x3e253e243e233e22,0x3e283e273e273e26,0x3e2c3e2b3e2a3e29,0x3e2f3e2e3e2d3e2d,0x3e333e323e313e30
.quad 0x3e363e353e353e34,0x3e3a3e393e383e37,0x3e3d3e3c3e3c3e3b,0x3e413e403e3f3e3e,0x3e443e443e433e42,0x3e483e473e463e45,0x3e4c3e4b3e4a3e49,0x3e4f3e4e3e4d3e4c
.quad 0x3e563e543e523e51,0x3e5d3e5b3e5a3e58,0x3e653e633e613e5f,0x3e6c3e6a3e683e66,0x3e733e713e703e6e,0x3e7b3e793e773e75,0x3e813e803e7e3e7d,0x3e853e843e833e82
.quad 0x3e893e883e873e86,0x3e8c3e8b3e8b3e8a,0x3e903e8f3e8e3e8d,0x3e943e933e923e91,0x3e983e973e963e95,0x3e9c3e9b3e9a3e99,0x3ea03e9f3e9e3e9d,0x3ea43ea33ea23ea1
.quad 0x3ea83ea73ea63ea5,0x3eac3eab3eaa3ea9,0x3eb03eaf3eae3ead,0x3eb43eb33eb23eb1,0x3eb83eb73eb63eb5,0x3ebc3ebb3eba3eb9,0x3ec03ebf3ebe3ebd,0x3ec43ec33ec23ec1
.quad 0x3ec83ec73ec63ec5,0x3ecc3ecb3eca3ec9,0x3ed03ecf3ece3ecd,0x3ed43ed33ed23ed1,0x3ed93ed83ed73ed5,0x3edd3edc3edb3eda,0x3ee13ee03edf3ede,0x3ee53ee43ee33ee2
.quad 0x3eed3eeb3ee93ee7,0x3ef63ef43ef23ef0,0x3eff3efd3efa3ef8,0x3f043f033f023f00,0x3f083f073f063f05,0x3f0d3f0c3f0a3f09,0x3f113f103f0f3f0e,0x3f163f153f133f12
.quad 0x3f1a3f193f183f17,0x3f1f3f1e3f1d3f1c,0x3f243f223f213f20,0x3f283f273f263f25,0x3f2d3f2c3f2b3f2a,0x3f323f313f2f3f2e,0x3f373f353f343f33,0x3f3c3f3a3f393f38
.quad 0x3f403f3f3f3e3f3d,0x3f453f443f433f42,0x3f4a3f493f483f47,0x3f4f3f4e3f4d3f4b,0x3f543f533f523f50,0x3f593f583f573f55,0x3f5e3f5d3f5c3f5b,0x3f633f623f613f60
.quad 0x3f693f673f663f65,0x3f6e3f6c3f6b3f6a,0x3f733f723f703f6f,0x3f783f773f763f74,0x3f7d3f7c3f7b3f79,0x3f813f813f803f7f,0x3f843f833f833f82,0x3f873f863f853f85
.quad 0x3f8c3f8a3f893f88,0x3f913f903f8e3f8d,0x3f973f953f943f92,0x3f9c3f9b3f993f98,0x3fa23fa03f9f3f9e,0x3fa73fa63fa53fa3,0x3fad3fac3faa3fa9,0x3fb33fb13fb03fae
.quad 0x3fb83fb73fb63fb4,0x3fbe3fbd3fbb3fba,0x3fc43fc33fc13fc0,0x3fca3fc83fc73fc6,0x3fd03fce3fcd3fcb,0x3fd63fd43fd33fd1,0x3fdc3fda3fd93fd7,0x3fe23fe03fdf3fdd
.quad 0x3fe83fe63fe53fe3,0x3fee3fec3feb3fe9,0x3ff43ff23ff13fef,0x3ffa3ff83ff73ff5,0x40003fff3ffd3ffb,0x4003400240024001,0x4006400540054004,0x4009400940084007
.quad 0x400c400c400b400a,0x400f400f400e400d,0x4013401240114010,0x4016401540144013,0x4019401840174016,0x401c401b401a401a,0x401f401e401e401d,0x4022402140214020
.quad 0x4028402740254023,0x402e402d402b402a,0x4035403340324030,0x403b403a40384036,0x40414040403e403d,0x4048404640454043,0x404e404d404b4049,0x4055405340514050
.quad 0x405b405940584056,0x40614060405e405c,0x4068406640644063,0x406e406c406b4069,0x407440734071406f,0x407a407940774076,0x4080407f407e407c,0x4084408340824081
.quad 0x4087408640854084,0x408a408940884087,0x408d408c408b408b,0x4090408f408e408e,0x4093409240924091,0x4096409540954094,0x4099409940984097,0x409c409c409b409a
.quad 0x40a0409f409e409d,0x40a340a240a140a0,0x40a640a540a440a3,0x40a940a840a740a6,0x40ac40ab40aa40aa,0x40af40ae40ad40ad,0x40b240b140b040b0,0x40b540b440b340b3
.quad 0x40bb40b940b840b6,0x40c140bf40be40bc,0x40c740c540c440c2,0x40cd40cb40ca40c8,0x40d340d140d040ce,0x40d940d740d640d4,0x40df40dd40dc40da,0x40e540e340e240e0
.quad 0x40ea40e940e840e6,0x40f040ef40ed40ec,0x40f640f540f340f2,0x40fc40fb40f940f8,0x4101410040ff40fe,0x4104410341024102,0x4107410641054105,0x410a410941084108
.quad 0x410d410c410b410b,0x4110410f410e410d,0x4113411241114110,0x4115411541144113,0x4118411841174116,0x411b411b411a4119,0x411e411d411d411c,0x412141204120411f
.quad 0x4124412341234122,0x4127412641254125,0x412a412941284128,0x412d412c412b412a,0x4130412f412e412d,0x4132413241314130,0x4135413541344133,0x4138413841374136
.quad 0x413e413c413b4139,0x414341424141413f,0x4149414841464145,0x414f414e414c414b,0x4155415341524150,0x415b415941584156,0x4160415f415d415c,0x4166416541634162
.quad 0x416c416a41694168,0x41724170416f416d,0x4177417641754173,0x417d417c417a4179,0x418141814180417f,0x4184418441834182,0x4187418741864185,0x418a418941894188
.quad 0x418d418c418c418b,0x4190418f418e418e,0x4193419241914191,0x4196419541944194,0x4199419841974196,0x419b419b419a4199,0x419e419e419d419c,0x41a141a041a0419f
.quad 0x41a441a341a341a2,0x41a741a641a641a5,0x41aa41a941a841a8,0x41ad41ac41ab41ab,0x41b041af41ae41ad,0x41b341b241b141b0,0x41b541b541b441b3,0x41b841b841b741b6
.quad 0x41be41bc41bb41b9,0x41c341c241c141bf,0x41c941c841c641c5,0x41cf41ce41cc41cb,0x41d541d341d241d0,0x41db41d941d841d6,0x41e041df41dd41dc,0x41e641e541e341e2
.quad 0x41ec41ea41e941e8,0x41f241f041ef41ed,0x41f741f641f541f3,0x41fd41fc41fa41f9,0x42014201420041ff,0x4204420442034202,0x4207420742064205,0x420a420942094208
.quad 0x420d420c420c420b,0x4210420f420e420e,0x4213421242114211,0x4216421542144214,0x4219421842174216,0x421b421b421a4219,0x421e421e421d421c,0x422142204220421f
.quad 0x4224422342234222,0x4227422642264225,0x422a422942284228,0x422d422c422b422b,0x4230422f422e422d,0x4233423242314230,0x4235423542344233,0x4238423842374236
.quad 0xbeacbeadbeafbeb0,0xbea8bea9beaabeab,0xbea4bea5bea6bea7,0xbe9fbea0bea1bea2,0xbe9abe9cbe9dbe9e,0xbe96be97be98be99,0xbe91be92be94be95,0xbe8dbe8ebe8fbe90
.quad 0xbe88be89be8abe8c,0xbe84be85be86be87,0xbe7ebe80be81be82,0xbe75be77be7abe7c,0xbe6cbe6fbe71be73,0xbe64be66be68be6a,0xbe5bbe5ebe60be62,0xbe53be55be57be59
.quad 0xbe4bbe4dbe4fbe51,0xbe43be45be47be49,0xbe3cbe3ebe3fbe41,0xbe34be36be38be3a,0xbe2dbe2fbe30be32,0xbe26be28be29be2b,0xbe1fbe21be22be24,0xbe18be1abe1cbe1d
.quad 0xbe12be14be15be17,0xbe0cbe0dbe0fbe10,0xbe06be07be09be0a,0xbe00be01be03be04,0xbdf5bdf8bdfabdfd,0xbdeabdedbdefbdf2,0xbde0bde2bde5bde7,0xbdd6bdd8bddbbddd
.quad 0xbdc4bdc9bdcdbdd2,0xbdb3bdb7bdbbbdc0,0xbda3bda7bdaabdaf,0xbd94bd97bd9bbd9f,0xbd86bd8abd8dbd90,0xbd74bd7abd80bd83,0xbd5dbd62bd68bd6e,0xbd48bd4dbd52bd58
.quad 0xbd35bd3abd3fbd43,0xbd24bd28bd2cbd31,0xbd14bd18bd1cbd20,0xbd06bd09bd0dbd11,0xbcf2bcf8bcffbd03,0xbcdabce0bce6bcec,0xbcc5bccabccfbcd5,0xbcb2bcb6bcbbbcc0
.quad 0xbca0bca4bca9bcad,0xbc90bc94bc98bc9c,0xbc82bc85bc89bc8c,0xbc6abc70bc76bc7d,0xbc52bc58bc5ebc64,0xbc3dbc42bc47bc4d,0xbc2abc2fbc33bc38,0xbc19bc1dbc21bc26
.quad 0xbc09bc0dbc11bc15,0xbbf7bbfdbc02bc06,0xbbddbbe3bbeabbf0,0xbbc7bbccbbd2bbd7,0xbbb2bbb7bbbcbbc1,0xbba0bba4bba9bbad,0xbb8fbb93bb97bb9c,0xbb81bb84bb88bb8c
.quad 0xbb51bb5dbb6abb77,0xbb28bb32bb3cbb46,0xbb07bb0ebb17bb1f,0xbad8bae4baf1baff,0xbaadbab7bac1bacc,0xba8aba92ba9bbaa3,0xba5dba6aba77ba83,0xba31ba3bba46ba51
.quad 0xba0dba15ba1eba27,0xb9e1b9eeb9fcba05,0xb9b3b9beb9c9b9d5,0xb98fb997b9a0b9a9,0xb964b971b97fb987,0xb935b940b94bb957,0xb910b919b922b92b,0xb8e6b8f3b901b908
.quad 0xb8b7b8c1b8cdb8d9,0xb891b89ab8a3b8ac,0xb866b874b881b889,0xb837b842b84db85a,0xb811b81ab823b82d,0xb7e7b7f4b801b809,0xb7b7b7c2b7cdb7da,0xb791b79ab7a3b7ad
.quad 0xb766b774b781b789,0xb736b741b74db759,0xb710b719b722b72c,0xb6e5b6f2b700b708,0xb6b5b6c0b6ccb6d8,0xb68fb698b6a1b6ab,0xb663b671b67fb687,0xb634b63eb64ab656
.quad 0xb5e7b602b612b624,0xb591b5a3b5b7b5ce,0xb535b54bb564b580,0xb4e1b4fdb50fb520,0xb48cb49eb4b2b4c8,0xb42fb445b45eb47a,0xb3dab3f5b40ab41b,0xb388b399b3acb3c1
.quad 0xb329b33eb356b371,0xb2d1b2ecb305b316,0xb282b293b2a5b2ba,0xb221b236b24db267,0xb1c8b1e2b1feb20f,0xb178b18cb19eb1b2,0xb11ab12eb144b15c,0xb0bfb0d7b0f2b109
.quad 0xb06cb085b096b0a9,0xb012b025b03ab052,0xafb5afccafe6b002,0xaf60af7caf8eafa0,0xaf0aaf1caf30af46,0xaeabaec1aedaaef5,0xae53ae6eae86ae98,0xae02ae13ae26ae3b
.quad 0xada1adb6adcdade7,0xad47ad60ad7dad8f,0xacf5ad0aad1cad30,0xac97acabacc1acd9,0xac3bac53ac6eac86,0xabe6ac02ac13ac25,0xab8eaba0abb5abcc,0xab2fab45ab5fab7b
.quad 0xaa8daab4aae5ab12,0xa9d6aa08aa2eaa5d,0xa922a94ea984a9a8,0xa875a89ca8c7a8fe,0xa7b9a7eca817a840,0xa70ca733a764a791,0xa654a687a6aca6dc,0xa5a0a5cca602a626
.quad 0xa4f1a51aa544a57a,0xa436a468a494a4bd,0xa389a3afa3dfa40e,0xa2cea303a328a356,0xa21ba246a27da2a1,0xa169a195a1bea1f3,0xa0afa0e0a10fa137,0xa004a028a057a089
.quad 0x9f469f7d9fa19fce,0x9e959ebe9ef29f1b,0x9ddf9e0e9e369e69,0x9d279d569d899dae,0x9c7b9ca09ccd9d03,0x9bbc9bf09c1a9c44,0x9b0d9b349b669b93,0x9a539a879aad9add
.quad 0x999e99ca9a019a25,0x98ed991799429977,0x98319863989198b9,0x978597aa97d9980b,0x96c696fe9722974f,0x9614963e9673969b,0x955e958e95b595e8,0x94a694d49508952d
.quad 0x935193ab940c9465,0x91ea923f929c9300,0x908290d5912e918f,0x8f118f6d8fc2901f,0x8da18e048e588eb1,0x8c338c938cf18d45,0x8ac78b238b868bdb,0x895e89b58a158a74
.quad 0x87f6884988a58907,0x868886df87378796,0x8517857885cb8626,0x83a78409846184b8,0x8239829882f9834c,0x80cd8128818a81e2,0x801c802f804c807d,0x80048006800b8011
.quad 0x8001800180018002,0x8000800080008000,0x8000800080008000,0x8000800080008000,0x8000800080008000,0x8000800080008000,0x8000800080008000,0x8000800080008000
.quad 0x8000800080008000,0x8000800080008000,0x8000800080008000,0x8000800080008000,0x8000800080008000,0x8000800080008000,0x8000800080008000,0x8000800080008000
.quad 0x0,0x0,0x0,0x0,0x0,0x0,0x0,0x0
.quad 0x0,0x0,0x0,0x0,0x0,0x0,0x0,0x0
.quad 0x0,0x0,0x0,0x0,0x0,0x0,0x0,0x0
.quad 0x0,0x0,0x0,0x0,0x0,0x0,0x0,0x0
.quad 0x0,0x0,0x0,0x0,0x0,0x0,0x0,0x0
.quad 0x0,0x0,0x0,0x0,0x0,0x0,0x0,0x0
.quad 0x0,0x0,0x0,0x0,0x0,0x0,0x0,0x0
.quad 0x0,0x0,0x0,0x0,0x0,0x0,0x0,0x0
.quad 0x7e3e7e3c7e3b7e39,0x7e437e427e417e3f,0x7e497e487e467e45,0x7e4f7e4e7e4c7e4b,0x7e557e537e527e50,0x7e5b7e597e587e56,0x7e607e5f7e5d7e5c,0x7e667e657e637e62
.quad 0x7e6c7e6a7e697e68,0x7e727e707e6f7e6d,0x7e777e767e757e73,0x7e7d7e7c7e7a7e79,0x7e817e817e807e7f,0x7e847e847e837e82,0x7e877e877e867e85,0x7e8a7e897e897e88
.quad 0x7e8d7e8c7e8c7e8b,0x7e907e8f7e8e7e8e,0x7e937e927e917e91,0x7e967e957e947e94,0x7e997e987e977e96,0x7e9b7e9b7e9a7e99,0x7e9e7e9e7e9d7e9c,0x7ea17ea07ea07e9f
.quad 0x7ea47ea37ea37ea2,0x7ea77ea67ea67ea5,0x7eaa7ea97ea87ea8,0x7ead7eac7eab7eab,0x7eb07eaf7eae7ead,0x7eb37eb27eb17eb0,0x7eb57eb57eb47eb3,0x7eb87eb87eb77eb6
.quad 0x7ebe7ebc7ebb7eb9,0x7ec37ec27ec17ebf,0x7ec97ec87ec67ec5,0x7ecf7ece7ecc7ecb,0x7ed57ed37ed27ed0,0x7edb7ed97ed87ed6,0x7ee07edf7edd7edc,0x7ee67ee57ee37ee2
.quad 0x7eec7eea7ee97ee8,0x7ef27ef07eef7eed,0x7ef77ef67ef57ef3,0x7efd7efc7efa7ef9,0x7f017f017f007eff,0x7f047f047f037f02,0x7f077f077f067f05,0x7f0a7f097f097f08
.quad 0x7f0d7f0c7f0c7f0b,0x7f107f0f7f0e7f0e,0x7f137f127f117f11,0x7f167f157f147f14,0x7f197f187f177f16,0x7f1b7f1b7f1a7f19,0x7f1e7f1e7f1d7f1c,0x7f217f207f207f1f
.quad 0x7f247f237f237f22,0x7f277f267f267f25,0x7f2a7f297f287f28,0x7f2d7f2c7f2b7f2b,0x7f307f2f7f2e7f2d,0x7f337f327f317f30,0x7f357f357f347f33,0x7f387f387f377f36
.quad 0x7f3e7f3c7f3b7f39,0x7f437f427f417f3f,0x7f497f487f467f45,0x7f4f7f4e7f4c7f4b,0x7f557f537f527f50,0x7f5b7f597f587f56,0x7f607f5f7f5d7f5c,0x7f667f657f637f62
.quad 0x7f6c7f6a7f697f68,0x7f727f707f6f7f6d,0x7f777f767f757f73,0x7f7d7f7c7f7a7f79,0x7f807f807f807f7f,0x7f807f807f807f80,0x7f807f807f807f80,0x7f807f807f807f80
.quad 0x7f807f807f807f80,0x7f807f807f807f80,0x7f807f807f807f80,0x7f807f807f807f80,0x7f807f807f807f80,0x7f807f807f807f80,0x7f807f807f807f80,0x7f807f807f807f80
.quad 0x7f807f807f807f80,0x7f807f807f807f80,0x7f807f807f807f80,0x7f807f807f807f80,0x7f807f807f807f80,0x7f807f807f807f80,0x7f807f807f807f80,0x7f807f807f807f80
.quad 0x7fc07fc07fc07f80,0x7fc07fc07fc07fc0,0x7fc07fc07fc07fc0,0x7fc07fc07fc07fc0,0x7fc07fc07fc07fc0,0x7fc07fc07fc07fc0,0x7fc07fc07fc07fc0,0x7fc07fc07fc07fc0
.quad 0x7fc07fc07fc07fc0,0x7fc07fc07fc07fc0,0x7fc07fc07fc07fc0,0x7fc07fc07fc07fc0,0x7fc07fc07fc07fc0,0x7fc07fc07fc07fc0,0x7fc07fc07fc07fc0,0x7fc07fc07fc07fc0
.quad 0x7fc07fc07fc07fc0,0x7fc07fc07fc07fc0,0x7fc07fc07fc07fc0,0x7fc07fc07fc07fc0,0x7fc07fc07fc07fc0,0x7fc07fc07fc07fc0,0x7fc07fc07fc07fc0,0x7fc07fc07fc07fc0
.quad 0x7fc07fc07fc07fc0,0x7fc07fc07fc07fc0,0x7fc07fc07fc07fc0,0x7fc07fc07fc07fc0,0x7fc07fc07fc07fc0,0x7fc07fc07fc07fc0,0x7fc07fc07fc07fc0,0x7fc07fc07fc07fc0
.quad 0x8003800280010000,0x8005800580048003,0x8008800880078006,0x800b800a800a8009,0x800e800d800d800c,0x801180108010800f,0x8014801380128012,0x8017801680158015
.quad 0x801a801980188017,0x801c801c801b801a,0x801f801f801e801d,0x8022802280218020,0x8025802480248023,0x8028802780278026,0x802b802a80298029,0x802e802d802c802c
.quad 0x80318030802f802f,0x8034803380328031,0x8036803680358034,0x8039803980388037,0x803c803c803b803a,0x803f803e803e803d,0x8042804180418040,0x8045804480438043
.quad 0x8048804780468046,0x804b804a80498048,0x804e804d804c804b,0x80508050804f804e,0x8053805380528051,0x8056805580558054,0x8059805880588057,0x805c805b805b805a
.quad 0x805f805e805d805d,0x8062806180608060,0x8065806480638062,0x8068806780668065,0x806a806a80698068,0x806d806d806c806b,0x8070806f806f806e,0x8073807280728071
.quad 0x8076807580748074,0x8079807880778077,0x807c807b807a807a,0x807f807e807d807c,0x808180818080807f,0x8084808480838082,0x8087808780868085,0x808a808980898088
.quad 0x808d808c808c808b,0x8090808f808e808e,0x8093809280918091,0x8096809580948094,0x8099809880978096,0x809b809b809a8099,0x809e809e809d809c,0x80a180a080a0809f
.quad 0x80a480a380a380a2,0x80a780a680a680a5,0x80aa80a980a880a8,0x80ad80ac80ab80ab,0x80b080af80ae80ad,0x80b380b280b180b0,0x80b580b580b480b3,0x80b880b880b780b6
.quad 0x80be80bc80bb80b9,0x80c380c280c180bf,0x80c980c880c680c5,0x80cf80ce80cc80cb,0x80d580d380d280d0,0x80db80d980d880d6,0x80e080df80dd80dc,0x80e680e580e380e2
.quad 0x80ec80ea80e980e8,0x80f280f080ef80ed,0x80f780f680f580f3,0x80fd80fc80fa80f9,0x81018101810080ff,0x8104810481038102,0x8107810781068105,0x810a810981098108
.quad 0x810d810c810c810b,0x8110810f810e810e,0x8113811281118111,0x8116811581148114,0x8119811881178116,0x811b811b811a8119,0x811e811e811d811c,0x812181208120811f
.quad 0x8124812381238122,0x8127812681268125,0x812a812981288128,0x812d812c812b812b,0x8130812f812e812d,0x8133813281318130,0x8135813581348133,0x8138813881378136
.quad 0x813e813c813b8139,0x814381428141813f,0x8149814881468145,0x814f814e814c814b,0x8155815381528150,0x815b815981588156,0x8160815f815d815c,0x8166816581638162
.quad 0x816c816a81698168,0x81728170816f816d,0x8177817681758173,0x817d817c817a8179,0x818181818180817f,0x8184818481838182,0x8187818781868185,0x818a818981898188
.quad 0x818d818c818c818b,0x8190818f818e818e,0x8193819281918191,0x8196819581948194,0x8199819881978196,0x819b819b819a8199,0x819e819e819d819c,0x81a181a081a0819f
.quad 0x81a481a381a381a2,0x81a781a681a681a5,0x81aa81a981a881a8,0x81ad81ac81ab81ab,0x81b081af81ae81ad,0x81b381b281b181b0,0x81b581b581b481b3,0x81b881b881b781b6
.quad 0x35be35bc35bb35b9,0x35c335c235c135bf,0x35c935c835c635c5,0x35cf35ce35cc35cb,0x35d535d335d235d0,0x35db35d935d835d6,0x35e035df35dd35dc,0x35e635e535e335e2
.quad 0x35ec35ea35e935e8,0x35f235f035ef35ed,0x35f735f635f535f3,0x35fd35fc35fa35f9,0x36013601360035ff,0x3604360436033602,0x3607360736063605,0x360a360936093608
.quad 0x360d360c360c360b,0x3610360f360e360e,0x3613361236113611,0x3616361536143614,0x3619361836173616,0x361b361b361a3619,0x361e361e361d361c,0x362136213620361f
.quad 0x3624362336233622,0x3627362636263625,0x362a362936283628,0x362d362c362b362b,0x3630362f362e362d,0x3633363236313630,0x3635363536343633,0x3638363836373636
.quad 0x363e363c363b3639,0x364336423641363f,0x3649364836463645,0x364f364e364c364b,0x3655365336523650,0x365b365936583656,0x3660365f365d365c,0x3666366536633662
.quad 0x366c366a36693668,0x36723670366f366d,0x3677367636753673,0x367d367c367a3679,0x368136813680367f,0x3684368436833682,0x3687368736863685,0x368a368936893688
.quad 0x368d368c368c368b,0x3690368f368e368e,0x3693369236913691,0x3696369536943694,0x3699369836973696,0x369b369b369a3699,0x369e369e369d369c,0x36a136a136a0369f
.quad 0x36a436a336a336a2,0x36a736a636a636a5,0x36aa36a936a836a8,0x36ad36ac36ab36ab,0x36b036af36ae36ad,0x36b336b236b136b0,0x36b536b536b436b3,0x36b836b836b736b6
.quad 0x36be36bc36bb36b9,0x36c336c236c136bf,0x36c936c836c636c5,0x36cf36ce36cc36cb,0x36d536d336d236d0,0x36db36d936d836d6,0x36e036df36dd36dc,0x36e636e536e336e2
.quad 0x36ec36ea36e936e8,0x36f236f036ef36ed,0x36f736f636f536f3,0x36fd36fc36fa36f9,0x37013701370036ff,0x3704370437033702,0x3707370737063705,0x370a370937093708
.quad 0x370d370c370c370b,0x3710370f370e370e,0x3713371237113711,0x3716371537143714,0x3719371837173716,0x371b371b371a3719,0x371e371e371d371c,0x372137213720371f
.quad 0x3724372337233722,0x3727372637263725,0x372a372937283728,0x372d372c372b372b,0x3730372f372e372d,0x3733373237313730,0x3735373537343733,0x3738373837373736
.quad 0x373e373c373b3739,0x374337423741373f,0x3749374837463745,0x374f374e374c374b,0x3755375337523750,0x375b375937583756,0x3760375f375d375c,0x3766376537633762
.quad 0x376c376a37693768,0x37723770376f376d,0x3777377637753773,0x377d377c377a3779,0x378137813780377f,0x3784378437833782,0x3787378737863785,0x378a378937893788
.quad 0x378d378c378c378b,0x3790378f378e378e,0x3793379237913791,0x3796379537943794,0x3799379837973796,0x379b379b379a3799,0x379e379e379d379c,0x37a137a137a0379f
.quad 0x37a437a337a337a2,0x37a737a637a637a5,0x37aa37a937a837a8,0x37ad37ac37ab37ab,0x37b037af37ae37ad,0x37b337b237b137b0,0x37b537b537b437b3,0x37b837b837b737b6
.quad 0xb5beb5bcb5bbb5b9,0xb5c3b5c2b5c1b5bf,0xb5c9b5c8b5c6b5c5,0xb5cfb5ceb5ccb5cb,0xb5d5b5d3b5d2b5d0,0xb5dbb5d9b5d8b5d6,0xb5e0b5dfb5ddb5dc,0xb5e6b5e5b5e3b5e2
.quad 0xb5ecb5eab5e9b5e8,0xb5f2b5f0b5efb5ed,0xb5f7b5f6b5f5b5f3,0xb5fdb5fcb5fab5f9,0xb601b601b600b5ff,0xb604b604b603b602,0xb607b607b606b605,0xb60ab609b609b608
.quad 0xb60db60cb60cb60b,0xb610b60fb60eb60e,0xb613b612b611b611,0xb616b615b614b614,0xb619b618b617b616,0xb61bb61bb61ab619,0xb61eb61eb61db61c,0xb621b620b620b61f
.quad 0xb624b623b623b622,0xb627b626b626b625,0xb62ab629b628b628,0xb62db62cb62bb62b,0xb630b62fb62eb62d,0xb633b632b631b630,0xb635b635b634b633,0xb638b638b637b636
.quad 0xb63eb63cb63bb639,0xb643b642b641b63f,0xb649b648b646b645,0xb64fb64eb64cb64b,0xb655b653b652b650,0xb65bb659b658b656,0xb660b65fb65db65c,0xb666b665b663b662
.quad 0xb66cb66ab669b668,0xb672b670b66fb66d,0xb677b676b675b673,0xb67db67cb67ab679,0xb681b681b680b67f,0xb684b684b683b682,0xb687b687b686b685,0xb68ab689b689b688
.quad 0xb68db68cb68cb68b,0xb690b68fb68eb68e,0xb693b692b691b691,0xb696b695b694b694,0xb699b698b697b696,0xb69bb69bb69ab699,0xb69eb69eb69db69c,0xb6a1b6a0b6a0b69f
.quad 0xb6a4b6a3b6a3b6a2,0xb6a7b6a6b6a6b6a5,0xb6aab6a9b6a8b6a8,0xb6adb6acb6abb6ab,0xb6b0b6afb6aeb6ad,0xb6b3b6b2b6b1b6b0,0xb6b5b6b5b6b4b6b3,0xb6b8b6b8b6b7b6b6
.quad 0xb6beb6bcb6bbb6b9,0xb6c3b6c2b6c1b6bf,0xb6c9b6c8b6c6b6c5,0xb6cfb6ceb6ccb6cb,0xb6d5b6d3b6d2b6d0,0xb6dbb6d9b6d8b6d6,0xb6e0b6dfb6ddb6dc,0xb6e6b6e5b6e3b6e2
.quad 0xb6ecb6eab6e9b6e8,0xb6f2b6f0b6efb6ed,0xb6f7b6f6b6f5b6f3,0xb6fdb6fcb6fab6f9,0xb701b701b700b6ff,0xb704b704b703b702,0xb707b707b706b705,0xb70ab709b709b708
.quad 0xb70db70cb70cb70b,0xb710b70fb70eb70e,0xb713b712b711b711,0xb716b715b714b714,0xb719b718b717b716,0xb71bb71bb71ab719,0xb71eb71eb71db71c,0xb721b720b720b71f
.quad 0xb724b723b723b722,0xb727b726b726b725,0xb72ab729b728b728,0xb72db72cb72bb72b,0xb730b72fb72eb72d,0xb733b732b731b730,0xb735b735b734b733,0xb738b738b737b736
.quad 0xb73eb73cb73bb739,0xb743b742b741b73f,0xb749b748b746b745,0xb74fb74eb74cb74b,0xb755b753b752b750,0xb75bb759b758b756,0xb760b75fb75db75c,0xb766b765b763b762
.quad 0xb76cb76ab769b768,0xb772b770b76fb76d,0xb777b776b775b773,0xb77db77cb77ab779,0xb781b781b780b77f,0xb784b784b783b782,0xb787b787b786b785,0xb78ab789b789b788
.quad 0xb78db78cb78cb78b,0xb790b78fb78eb78e,0xb793b792b791b791,0xb796b795b794b794,0xb799b798b797b796,0xb79bb79bb79ab799,0xb79eb79eb79db79c,0xb7a1b7a0b7a0b79f
.quad 0xb7a4b7a3b7a3b7a2,0xb7a7b7a6b7a6b7a5,0xb7aab7a9b7a8b7a8,0xb7adb7acb7abb7ab,0xb7b0b7afb7aeb7ad,0xb7b3b7b2b7b1b7b0,0xb7b5b7b5b7b4b7b3,0xb7b8b7b8b7b7b7b6
.size silu_table, .-silu_table
.section .rodata,"a"
.p2align 6
.amdhsa_kernel standalone__cheap_equivariant_egnn__graph_kernel
  .amdhsa_next_free_vgpr 252
  .amdhsa_next_free_sgpr 102
  .amdhsa_accum_offset 252
  .amdhsa_group_segment_fixed_size 0
  .amdhsa_kernarg_size 88
  .amdhsa_user_sgpr_count 2
  .amdhsa_user_sgpr_kernarg_segment_ptr 1
  .amdhsa_system_sgpr_workgroup_id_x 1
  .amdhsa_float_denorm_mode_32 3
.end_amdhsa_kernel
```
